```python
import torch

def _softmax(x, axis=-1):
    return torch.softmax(x, dim=axis)
def _gelu(x):
    return torch.nn.functional.gelu(x, approximate="tanh")
def _silu(x):
    return torch.nn.functional.silu(x)
def _sigmoid(x):
    return torch.sigmoid(x)
def _layernorm(x, axis=-1, eps=1e-5):
    m = x.mean(dim=axis, keepdim=True)
    v = x.var(dim=axis, keepdim=True, unbiased=False)
    return (x - m) / torch.sqrt(v + eps)
def _scatter_add(tgt, idx, src, axis=0):
    return tgt.clone().index_add_(axis, idx, src)
def _segment_sum(src, seg, n):
    out = torch.zeros((n,) + src.shape[1:], dtype=src.dtype)
    return out.index_add_(0, seg, src)
def _pad(x, pw):
    flat = tuple(v for pair in reversed(pw) for v in pair)
    return torch.nn.functional.pad(x, flat)

kernel_name = 'recurrent_scan__gqa_block_cached__geglu_ffn__decode'

def setup_inputs():

    _w = (lambda a: (lambda t: t.to(torch.bfloat16) if t.is_floating_point() else t)(torch.as_tensor(a)))
    def _A_setup():
        B, Sq, D = 2, 1, 512
        Hq, Hkv, Sk, Dh = 32, 32, 8192, 128
        assert Hq % Hkv == 0, (Hq, Hkv)
        return {
            "x": _w((lambda *s: torch.randn(*s, dtype=torch.bfloat16) * 0.05)(B, Sq, D)),
            "k_cache": _w((lambda *s: torch.randn(*s, dtype=torch.bfloat16) * 1.6)(B, Hkv, Sk, Dh)),
            "v_cache": _w((lambda *s: torch.randn(*s, dtype=torch.bfloat16) * 0.2)(B, Hkv, Sk, Dh)),
            "wq": _w((lambda *s: torch.randn(*s, dtype=torch.bfloat16) * 1.6)(D, Hq * Dh) * (D ** -0.5)),
            "wo": _w((lambda *s: torch.randn(*s, dtype=torch.bfloat16) * 0.2)(Hq * Dh, D) * ((Hq * Dh) ** -0.5)),
        }
    _A_in = _A_setup()

    def _B_setup():
        B, S, D, F = 2, 1, 512, 1376
        return {
            "x": _w((lambda *s: torch.randn(*s, dtype=torch.bfloat16) * 0.05)(B, S, D)),
            "w_gate": _w((lambda *s: torch.randn(*s, dtype=torch.bfloat16) * 0.1)(D, F)),
            "w_up": _w((lambda *s: torch.randn(*s, dtype=torch.bfloat16) * 0.1)(D, F)),
            "w_down": _w((lambda *s: torch.randn(*s, dtype=torch.bfloat16) * 0.1)(F, D)),
        }
    _B_in = _B_setup()

    return {
        "A_x": _A_in["x"],
        "A_k_cache": _A_in["k_cache"],
        "A_v_cache": _A_in["v_cache"],
        "A_wq": _A_in["wq"],
        "A_wo": _A_in["wo"],
        "B_x": _B_in["x"],
        "B_w_gate": _B_in["w_gate"],
        "B_w_up": _B_in["w_up"],
        "B_w_down": _B_in["w_down"],
    }

def reference(A_x, A_k_cache, A_v_cache, A_wq, A_wo, B_x, B_w_gate, B_w_up, B_w_down):
    def _A_ref(x, k_cache, v_cache, wq, wo):
        B, Sq, D = x.shape
        Hq, Dh = 32, 128
        Hkv = k_cache.shape[1]
        rep = Hq // Hkv
        q = (lambda x, *d: x.permute(*d))((x @ wq).reshape(B, Sq, Hq, Dh), 0, 2, 1, 3)
        k = (lambda x, n, axis: torch.repeat_interleave(x, n, dim=axis))(k_cache, rep, axis=1)
        v = (lambda x, n, axis: torch.repeat_interleave(x, n, dim=axis))(v_cache, rep, axis=1)
        scores = torch.einsum("bhqd,bhkd->bhqk", q, k) * (Dh ** -0.5)
        p = _softmax(scores, axis=-1)
        o = torch.einsum("bhqk,bhkd->bhqd", p, v)
        return (lambda x, *d: x.permute(*d))(o, 0, 2, 1, 3).reshape(B, Sq, Hq * Dh) @ wo

    def _B_ref(x, w_gate, w_up, w_down):
        return (_gelu(x @ w_gate) * (x @ w_up)) @ w_down

    x = A_x
    xn = _layernorm(x, axis=-1)
    s = _A_ref(xn, A_k_cache, A_v_cache, A_wq, A_wo)
    g = _silu(_B_ref(xn, B_w_gate, B_w_up, B_w_down))
    return x + s * g
```

```asm
; @launch kernel=recurrent_scan__gqa_block_cached__geglu_ffn__decode_kernel grid=(256,1,1) block=(1024,1,1) lds=55296
; @launch kernel=combine_kernel grid=(64,1,1) block=(256,1,1) lds=512
.amdgcn_target "amdgcn-amd-amdhsa--gfx950"
.text
.globl recurrent_scan__gqa_block_cached__geglu_ffn__decode_kernel
.p2align 8
.type recurrent_scan__gqa_block_cached__geglu_ffn__decode_kernel,@function
recurrent_scan__gqa_block_cached__geglu_ffn__decode_kernel:
  s_cmp_ge_u32 s2, 256
  s_cbranch_scc1 K1_END
  s_load_dwordx16 s[4:19], s[0:1], 0
  s_load_dwordx8 s[20:27], s[0:1], 64
  v_and_b32 v1, 63, v0
  v_lshrrev_b32 v3, 6, v0
  s_nop 0
  v_readfirstlane_b32 s60, v3
  s_and_b32 s61, s2, 31
  s_lshr_b32 s62, s2, 7
  s_bfe_u32 s63, s2, 0x20005
  s_and_b32 s64, s2, 0xc0
  s_and_b32 s66, s2, 7
  s_lshl_b32 s66, s66, 3
  s_add_u32 s64, s64, s66
  s_bfe_u32 s66, s2, 0x30003
  s_add_u32 s64, s64, s66
  s_cmp_lt_u32 s64, 172
  s_cselect_b32 s65, 1, 0
  v_lshrrev_b32 v47, 4, v1
  v_and_b32 v38, 1, v47
  v_lshlrev_b32 v38, 1, v38
  v_lshrrev_b32 v39, 1, v47
  v_or_b32 v38, v38, v39
  v_and_b32 v39, 15, v1
  v_lshl_add_u32 v46, v39, 3, v38
  s_waitcnt lgkmcnt(0)
  s_mov_b32 s44, s4
  s_and_b32 s45, s5, 0xffff
  s_mov_b32 s46, 0x800
  s_mov_b32 s47, 0x00020000
  s_mov_b32 s28, s6
  s_and_b32 s29, s7, 0xffff
  s_mov_b32 s30, 0x8000000
  s_mov_b32 s31, 0x00020000
  s_mov_b32 s32, s8
  s_and_b32 s33, s9, 0xffff
  s_mov_b32 s34, 0x8000000
  s_mov_b32 s35, 0x00020000
  s_mov_b32 s36, s10
  s_and_b32 s37, s11, 0xffff
  s_mov_b32 s38, 0x400000
  s_mov_b32 s39, 0x00020000
  s_mov_b32 s40, s12
  s_and_b32 s41, s13, 0xffff
  s_mov_b32 s42, 0x400000
  s_mov_b32 s43, 0x00020000
  s_mov_b32 s52, s20
  s_and_b32 s53, s21, 0xffff
  s_mov_b32 s54, 0x158000
  s_mov_b32 s55, 0x00020000
  s_mov_b32 s56, s26
  s_and_b32 s57, s27, 0xffff
  s_mov_b32 s58, 0x200000
  s_mov_b32 s59, 0x00020000
  s_cmp_lt_u32 s60, 8
  s_cselect_b32 s48, s16, s18
  s_cselect_b32 s49, s17, s19
  s_and_b32 s49, s49, 0xffff
  s_cmp_eq_u32 s65, 1
  s_cselect_b32 s50, 0x158000, 0
  s_mov_b32 s51, 0x00020000
  v_lshlrev_b32 v3, 4, v1
  buffer_load_dwordx4 v[8:11], v3, s[44:47], 0 offen
  buffer_load_dwordx4 v[12:15], v3, s[44:47], 0 offen offset:1024
  s_lshl_b32 s66, s60, 18
  s_lshl_b32 s67, s61, 8
  s_add_u32 s66, s66, s67
  v_lshlrev_b32 v38, 13, v47
  v_lshl_add_u32 v38, v39, 4, v38
  v_add_u32 v38, s66, v38
  s_mov_b32 s100, 0x0
  buffer_load_dwordx4 v[48:51], v38, s[36:39], s100 offen
  s_mov_b32 s100, 0x8000
  buffer_load_dwordx4 v[52:55], v38, s[36:39], s100 offen
  s_mov_b32 s100, 0x10000
  buffer_load_dwordx4 v[56:59], v38, s[36:39], s100 offen
  s_mov_b32 s100, 0x18000
  buffer_load_dwordx4 v[60:63], v38, s[36:39], s100 offen
  s_mov_b32 s100, 0x20000
  buffer_load_dwordx4 v[64:67], v38, s[36:39], s100 offen
  s_mov_b32 s100, 0x28000
  buffer_load_dwordx4 v[68:71], v38, s[36:39], s100 offen
  s_mov_b32 s100, 0x30000
  buffer_load_dwordx4 v[72:75], v38, s[36:39], s100 offen
  s_mov_b32 s100, 0x38000
  buffer_load_dwordx4 v[76:79], v38, s[36:39], s100 offen
  s_and_b32 s66, s60, 7
  s_lshl_b32 s66, s66, 6
  v_add_u32 v38, s66, v1
  s_movk_i32 s67, 2752
  v_mul_lo_u32 v38, v38, s67
  s_lshl_b32 s67, s64, 4
  v_add_u32 v38, s67, v38
  buffer_load_dwordx4 v[28:31], v38, s[48:51], 0 offen
  s_lshl_b32 s66, s62, 5
  s_add_u32 s66, s66, s61
  s_lshl_b32 s66, s66, 21
  s_lshl_b32 s67, s63, 19
  s_add_u32 s66, s66, s67
  s_lshl_b32 s67, s60, 15
  s_add_u32 s66, s66, s67
  v_add_u32 v2, s66, v3
  s_mul_i32 s101, s60, 3
  s_mul_i32 s67, s2, 1
  s_add_u32 s101, s101, s67
  s_and_b32 s101, s101, 31
  s_lshl_b32 s101, s101, 10
  buffer_load_dwordx4 v[80:83], v2, s[28:31], s101 offen nt
  s_add_u32 s101, s101, 0x400
  s_and_b32 s101, s101, 0x7fff
  buffer_load_dwordx4 v[84:87], v2, s[28:31], s101 offen nt
  s_add_u32 s101, s101, 0x400
  s_and_b32 s101, s101, 0x7fff
  buffer_load_dwordx4 v[88:91], v2, s[28:31], s101 offen nt
  s_add_u32 s101, s101, 0x400
  s_and_b32 s101, s101, 0x7fff
  buffer_load_dwordx4 v[92:95], v2, s[28:31], s101 offen nt
  s_add_u32 s101, s101, 0x400
  s_and_b32 s101, s101, 0x7fff
  buffer_load_dwordx4 v[96:99], v2, s[28:31], s101 offen nt
  s_add_u32 s101, s101, 0x400
  s_and_b32 s101, s101, 0x7fff
  buffer_load_dwordx4 v[100:103], v2, s[28:31], s101 offen nt
  s_add_u32 s101, s101, 0x400
  s_and_b32 s101, s101, 0x7fff
  buffer_load_dwordx4 v[104:107], v2, s[28:31], s101 offen nt
  s_add_u32 s101, s101, 0x400
  s_and_b32 s101, s101, 0x7fff
  buffer_load_dwordx4 v[108:111], v2, s[28:31], s101 offen nt
  s_add_u32 s101, s101, 0x400
  s_and_b32 s101, s101, 0x7fff
  buffer_load_dwordx4 v[112:115], v2, s[28:31], s101 offen nt
  s_add_u32 s101, s101, 0x400
  s_and_b32 s101, s101, 0x7fff
  buffer_load_dwordx4 v[116:119], v2, s[28:31], s101 offen nt
  s_add_u32 s101, s101, 0x400
  s_and_b32 s101, s101, 0x7fff
  buffer_load_dwordx4 v[120:123], v2, s[28:31], s101 offen nt
  s_add_u32 s101, s101, 0x400
  s_and_b32 s101, s101, 0x7fff
  buffer_load_dwordx4 v[124:127], v2, s[28:31], s101 offen nt
  s_add_u32 s101, s101, 0x400
  s_and_b32 s101, s101, 0x7fff
  s_waitcnt vmcnt(21)
  v_lshlrev_b32 v3, 5, v1
  v_lshlrev_b32 v32, 16, v8
  v_and_b32 v33, 0xffff0000, v8
  v_lshlrev_b32 v34, 16, v9
  v_and_b32 v35, 0xffff0000, v9
  v_lshlrev_b32 v36, 16, v10
  v_and_b32 v37, 0xffff0000, v10
  v_lshlrev_b32 v38, 16, v11
  v_and_b32 v39, 0xffff0000, v11
  v_add_f32 v40, v32, v33
  v_add_f32 v41, v34, v35
  v_add_f32 v43, v36, v37
  v_add_f32 v42, v38, v39
  v_add_f32 v40, v40, v41
  v_add_f32 v43, v43, v42
  v_add_f32 v40, v40, v43
  s_nop 1
  v_add_f32_dpp v40, v40, v40 quad_perm:[1,0,3,2] row_mask:0xf bank_mask:0xf
  s_nop 1
  v_add_f32_dpp v40, v40, v40 quad_perm:[2,3,0,1] row_mask:0xf bank_mask:0xf
  s_nop 1
  v_add_f32_dpp v40, v40, v40 row_half_mirror row_mask:0xf bank_mask:0xf
  s_nop 1
  v_add_f32_dpp v40, v40, v40 row_mirror row_mask:0xf bank_mask:0xf
  v_mov_b32 v41, v40
  s_nop 1
  v_permlane16_swap_b32 v40, v41
  v_add_f32 v40, v40, v41
  v_mov_b32 v41, v40
  s_nop 1
  v_permlane32_swap_b32 v40, v41
  v_add_f32 v40, v40, v41
  v_mul_f32 v42, 0x3b000000, v40
  v_sub_f32 v43, v32, v42
  v_mul_f32 v40, v43, v43
  v_sub_f32 v43, v33, v42
  v_fmac_f32 v40, v43, v43
  v_sub_f32 v43, v34, v42
  v_fmac_f32 v40, v43, v43
  v_sub_f32 v43, v35, v42
  v_fmac_f32 v40, v43, v43
  v_sub_f32 v43, v36, v42
  v_fmac_f32 v40, v43, v43
  v_sub_f32 v43, v37, v42
  v_fmac_f32 v40, v43, v43
  v_sub_f32 v43, v38, v42
  v_fmac_f32 v40, v43, v43
  v_sub_f32 v43, v39, v42
  v_fmac_f32 v40, v43, v43
  s_nop 1
  v_add_f32_dpp v40, v40, v40 quad_perm:[1,0,3,2] row_mask:0xf bank_mask:0xf
  s_nop 1
  v_add_f32_dpp v40, v40, v40 quad_perm:[2,3,0,1] row_mask:0xf bank_mask:0xf
  s_nop 1
  v_add_f32_dpp v40, v40, v40 row_half_mirror row_mask:0xf bank_mask:0xf
  s_nop 1
  v_add_f32_dpp v40, v40, v40 row_mirror row_mask:0xf bank_mask:0xf
  v_mov_b32 v41, v40
  s_nop 1
  v_permlane16_swap_b32 v40, v41
  v_add_f32 v40, v40, v41
  v_mov_b32 v41, v40
  s_nop 1
  v_permlane32_swap_b32 v40, v41
  v_add_f32 v40, v40, v41
  v_mul_f32 v40, 0x3b000000, v40
  v_cvt_pk_bf16_f32 v41, v42, v40
  v_lshlrev_b32 v42, 16, v41
  v_and_b32 v40, 0xffff0000, v41
  v_add_f32 v40, 0x3727c5ac, v40
  v_cvt_pk_bf16_f32 v41, v40, v40
  v_lshlrev_b32 v40, 16, v41
  v_sqrt_f32 v40, v40
  s_nop 0
  v_cvt_pk_bf16_f32 v41, v40, v40
  v_lshlrev_b32 v40, 16, v41
  v_rcp_f32 v43, v40
  v_sub_f32 v32, v32, v42
  v_sub_f32 v33, v33, v42
  v_cvt_pk_bf16_f32 v41, v32, v33
  v_lshlrev_b32 v32, 16, v41
  v_and_b32 v33, 0xffff0000, v41
  v_mul_f32 v44, v32, v43
  v_mul_f32 v45, v33, v43
  v_fma_f32 v32, -v44, v40, v32
  v_fma_f32 v33, -v45, v40, v33
  v_fma_f32 v32, v32, v43, v44
  v_fma_f32 v33, v33, v43, v45
  v_cvt_pk_bf16_f32 v41, v32, v33
  v_lshlrev_b32 v32, 16, v41
  v_and_b32 v33, 0xffff0000, v41
  v_sub_f32 v34, v34, v42
  v_sub_f32 v35, v35, v42
  v_cvt_pk_bf16_f32 v41, v34, v35
  v_lshlrev_b32 v34, 16, v41
  v_and_b32 v35, 0xffff0000, v41
  v_mul_f32 v44, v34, v43
  v_mul_f32 v45, v35, v43
  v_fma_f32 v34, -v44, v40, v34
  v_fma_f32 v35, -v45, v40, v35
  v_fma_f32 v34, v34, v43, v44
  v_fma_f32 v35, v35, v43, v45
  v_cvt_pk_bf16_f32 v41, v34, v35
  v_lshlrev_b32 v34, 16, v41
  v_and_b32 v35, 0xffff0000, v41
  v_sub_f32 v36, v36, v42
  v_sub_f32 v37, v37, v42
  v_cvt_pk_bf16_f32 v41, v36, v37
  v_lshlrev_b32 v36, 16, v41
  v_and_b32 v37, 0xffff0000, v41
  v_mul_f32 v44, v36, v43
  v_mul_f32 v45, v37, v43
  v_fma_f32 v36, -v44, v40, v36
  v_fma_f32 v37, -v45, v40, v37
  v_fma_f32 v36, v36, v43, v44
  v_fma_f32 v37, v37, v43, v45
  v_cvt_pk_bf16_f32 v41, v36, v37
  v_lshlrev_b32 v36, 16, v41
  v_and_b32 v37, 0xffff0000, v41
  v_sub_f32 v38, v38, v42
  v_sub_f32 v39, v39, v42
  v_cvt_pk_bf16_f32 v41, v38, v39
  v_lshlrev_b32 v38, 16, v41
  v_and_b32 v39, 0xffff0000, v41
  v_mul_f32 v44, v38, v43
  v_mul_f32 v45, v39, v43
  v_fma_f32 v38, -v44, v40, v38
  v_fma_f32 v39, -v45, v40, v39
  v_fma_f32 v38, v38, v43, v44
  v_fma_f32 v39, v39, v43, v45
  v_cvt_pk_bf16_f32 v41, v38, v39
  v_lshlrev_b32 v38, 16, v41
  v_and_b32 v39, 0xffff0000, v41
  ds_write_b128 v3, v[32:35] offset:0
  ds_write_b128 v3, v[36:39] offset:16
  v_lshlrev_b32 v32, 16, v12
  v_and_b32 v33, 0xffff0000, v12
  v_lshlrev_b32 v34, 16, v13
  v_and_b32 v35, 0xffff0000, v13
  v_lshlrev_b32 v36, 16, v14
  v_and_b32 v37, 0xffff0000, v14
  v_lshlrev_b32 v38, 16, v15
  v_and_b32 v39, 0xffff0000, v15
  v_add_f32 v40, v32, v33
  v_add_f32 v41, v34, v35
  v_add_f32 v43, v36, v37
  v_add_f32 v42, v38, v39
  v_add_f32 v40, v40, v41
  v_add_f32 v43, v43, v42
  v_add_f32 v40, v40, v43
  s_nop 1
  v_add_f32_dpp v40, v40, v40 quad_perm:[1,0,3,2] row_mask:0xf bank_mask:0xf
  s_nop 1
  v_add_f32_dpp v40, v40, v40 quad_perm:[2,3,0,1] row_mask:0xf bank_mask:0xf
  s_nop 1
  v_add_f32_dpp v40, v40, v40 row_half_mirror row_mask:0xf bank_mask:0xf
  s_nop 1
  v_add_f32_dpp v40, v40, v40 row_mirror row_mask:0xf bank_mask:0xf
  v_mov_b32 v41, v40
  s_nop 1
  v_permlane16_swap_b32 v40, v41
  v_add_f32 v40, v40, v41
  v_mov_b32 v41, v40
  s_nop 1
  v_permlane32_swap_b32 v40, v41
  v_add_f32 v40, v40, v41
  v_mul_f32 v42, 0x3b000000, v40
  v_sub_f32 v43, v32, v42
  v_mul_f32 v40, v43, v43
  v_sub_f32 v43, v33, v42
  v_fmac_f32 v40, v43, v43
  v_sub_f32 v43, v34, v42
  v_fmac_f32 v40, v43, v43
  v_sub_f32 v43, v35, v42
  v_fmac_f32 v40, v43, v43
  v_sub_f32 v43, v36, v42
  v_fmac_f32 v40, v43, v43
  v_sub_f32 v43, v37, v42
  v_fmac_f32 v40, v43, v43
  v_sub_f32 v43, v38, v42
  v_fmac_f32 v40, v43, v43
  v_sub_f32 v43, v39, v42
  v_fmac_f32 v40, v43, v43
  s_nop 1
  v_add_f32_dpp v40, v40, v40 quad_perm:[1,0,3,2] row_mask:0xf bank_mask:0xf
  s_nop 1
  v_add_f32_dpp v40, v40, v40 quad_perm:[2,3,0,1] row_mask:0xf bank_mask:0xf
  s_nop 1
  v_add_f32_dpp v40, v40, v40 row_half_mirror row_mask:0xf bank_mask:0xf
  s_nop 1
  v_add_f32_dpp v40, v40, v40 row_mirror row_mask:0xf bank_mask:0xf
  v_mov_b32 v41, v40
  s_nop 1
  v_permlane16_swap_b32 v40, v41
  v_add_f32 v40, v40, v41
  v_mov_b32 v41, v40
  s_nop 1
  v_permlane32_swap_b32 v40, v41
  v_add_f32 v40, v40, v41
  v_mul_f32 v40, 0x3b000000, v40
  v_cvt_pk_bf16_f32 v41, v42, v40
  v_lshlrev_b32 v42, 16, v41
  v_and_b32 v40, 0xffff0000, v41
  v_add_f32 v40, 0x3727c5ac, v40
  v_cvt_pk_bf16_f32 v41, v40, v40
  v_lshlrev_b32 v40, 16, v41
  v_sqrt_f32 v40, v40
  s_nop 0
  v_cvt_pk_bf16_f32 v41, v40, v40
  v_lshlrev_b32 v40, 16, v41
  v_rcp_f32 v43, v40
  v_sub_f32 v32, v32, v42
  v_sub_f32 v33, v33, v42
  v_cvt_pk_bf16_f32 v41, v32, v33
  v_lshlrev_b32 v32, 16, v41
  v_and_b32 v33, 0xffff0000, v41
  v_mul_f32 v44, v32, v43
  v_mul_f32 v45, v33, v43
  v_fma_f32 v32, -v44, v40, v32
  v_fma_f32 v33, -v45, v40, v33
  v_fma_f32 v32, v32, v43, v44
  v_fma_f32 v33, v33, v43, v45
  v_cvt_pk_bf16_f32 v41, v32, v33
  v_lshlrev_b32 v32, 16, v41
  v_and_b32 v33, 0xffff0000, v41
  v_sub_f32 v34, v34, v42
  v_sub_f32 v35, v35, v42
  v_cvt_pk_bf16_f32 v41, v34, v35
  v_lshlrev_b32 v34, 16, v41
  v_and_b32 v35, 0xffff0000, v41
  v_mul_f32 v44, v34, v43
  v_mul_f32 v45, v35, v43
  v_fma_f32 v34, -v44, v40, v34
  v_fma_f32 v35, -v45, v40, v35
  v_fma_f32 v34, v34, v43, v44
  v_fma_f32 v35, v35, v43, v45
  v_cvt_pk_bf16_f32 v41, v34, v35
  v_lshlrev_b32 v34, 16, v41
  v_and_b32 v35, 0xffff0000, v41
  v_sub_f32 v36, v36, v42
  v_sub_f32 v37, v37, v42
  v_cvt_pk_bf16_f32 v41, v36, v37
  v_lshlrev_b32 v36, 16, v41
  v_and_b32 v37, 0xffff0000, v41
  v_mul_f32 v44, v36, v43
  v_mul_f32 v45, v37, v43
  v_fma_f32 v36, -v44, v40, v36
  v_fma_f32 v37, -v45, v40, v37
  v_fma_f32 v36, v36, v43, v44
  v_fma_f32 v37, v37, v43, v45
  v_cvt_pk_bf16_f32 v41, v36, v37
  v_lshlrev_b32 v36, 16, v41
  v_and_b32 v37, 0xffff0000, v41
  v_sub_f32 v38, v38, v42
  v_sub_f32 v39, v39, v42
  v_cvt_pk_bf16_f32 v41, v38, v39
  v_lshlrev_b32 v38, 16, v41
  v_and_b32 v39, 0xffff0000, v41
  v_mul_f32 v44, v38, v43
  v_mul_f32 v45, v39, v43
  v_fma_f32 v38, -v44, v40, v38
  v_fma_f32 v39, -v45, v40, v39
  v_fma_f32 v38, v38, v43, v44
  v_fma_f32 v39, v39, v43, v45
  v_cvt_pk_bf16_f32 v41, v38, v39
  v_lshlrev_b32 v38, 16, v41
  v_and_b32 v39, 0xffff0000, v41
  ds_write_b128 v3, v[32:35] offset:2048
  ds_write_b128 v3, v[36:39] offset:2064
  s_waitcnt lgkmcnt(0)
  s_and_b32 s66, s60, 7
  s_lshl_b32 s66, s66, 8
  v_lshlrev_b32 v3, 2, v1
  v_add_u32 v3, s66, v3
  ds_read_b32 v8, v3 offset:0
  ds_read_b32 v9, v3 offset:2048
  s_waitcnt lgkmcnt(0)
  v_lshrrev_b32 v10, 16, v8
  v_lshrrev_b32 v11, 16, v9
  s_waitcnt vmcnt(12)
  v_dot2_f32_bf16 v12, v28, v10, 0
  v_dot2_f32_bf16 v13, v28, v8, 0
  v_dot2_f32_bf16 v14, v29, v10, 0
  v_dot2_f32_bf16 v15, v29, v8, 0
  v_dot2_f32_bf16 v16, v30, v10, 0
  v_dot2_f32_bf16 v17, v30, v8, 0
  v_dot2_f32_bf16 v18, v31, v10, 0
  v_dot2_f32_bf16 v19, v31, v8, 0
  v_dot2_f32_bf16 v20, v28, v11, 0
  v_dot2_f32_bf16 v21, v28, v9, 0
  v_dot2_f32_bf16 v22, v29, v11, 0
  v_dot2_f32_bf16 v23, v29, v9, 0
  v_dot2_f32_bf16 v24, v30, v11, 0
  v_dot2_f32_bf16 v25, v30, v9, 0
  v_dot2_f32_bf16 v26, v31, v11, 0
  v_dot2_f32_bf16 v27, v31, v9, 0
  v_permlane32_swap_b32 v12, v13
  v_permlane32_swap_b32 v14, v15
  v_permlane32_swap_b32 v16, v17
  v_permlane32_swap_b32 v18, v19
  v_permlane32_swap_b32 v20, v21
  v_permlane32_swap_b32 v22, v23
  v_permlane32_swap_b32 v24, v25
  v_permlane32_swap_b32 v26, v27
  v_add_f32 v12, v12, v13
  v_add_f32 v14, v14, v15
  v_add_f32 v16, v16, v17
  v_add_f32 v18, v18, v19
  v_add_f32 v20, v20, v21
  v_add_f32 v22, v22, v23
  v_add_f32 v24, v24, v25
  v_add_f32 v26, v26, v27
  v_permlane16_swap_b32 v12, v14
  v_permlane16_swap_b32 v16, v18
  v_permlane16_swap_b32 v20, v22
  v_permlane16_swap_b32 v24, v26
  v_add_f32 v12, v12, v14
  v_add_f32 v16, v16, v18
  v_add_f32 v20, v20, v22
  v_add_f32 v24, v24, v26
  v_add_f32_dpp v32, v12, v12 row_ror:8 row_mask:0xf bank_mask:0x3
  v_add_f32_dpp v32, v16, v16 row_ror:8 row_mask:0xf bank_mask:0xc
  v_add_f32_dpp v33, v20, v20 row_ror:8 row_mask:0xf bank_mask:0x3
  v_add_f32_dpp v33, v24, v24 row_ror:8 row_mask:0xf bank_mask:0xc
  v_add_f32_dpp v34, v32, v32 row_half_mirror row_mask:0xf bank_mask:0x5
  s_nop 0
  v_add_f32_dpp v34, v33, v33 row_half_mirror row_mask:0xf bank_mask:0xa
  s_nop 1
  v_add_f32_dpp v34, v34, v34 quad_perm:[1,0,3,2] row_mask:0xf bank_mask:0xf
  s_nop 1
  v_add_f32_dpp v34, v34, v34 quad_perm:[2,3,0,1] row_mask:0xf bank_mask:0xf
  v_bfe_u32 v35, v1, 2, 1
  v_bfe_u32 v38, v1, 3, 1
  v_lshl_add_u32 v35, v35, 1, v38
  v_and_b32 v38, 7, v46
  v_lshl_add_u32 v35, v35, 2, v38
  s_lshl_b32 s66, s60, 6
  v_lshlrev_b32 v35, 2, v35
  v_add_u32 v35, s66, v35
  ds_write_b32 v35, v34 offset:12544
  s_lshl_b32 s66, s62, 11
  s_lshl_b32 s67, s60, 7
  s_add_u32 s66, s66, s67
  v_lshlrev_b32 v3, 2, v47
  v_add_u32 v3, s66, v3
  ds_read_b32 v16, v3 offset:0
  ds_read_b32 v17, v3 offset:16
  ds_read_b32 v18, v3 offset:32
  ds_read_b32 v19, v3 offset:48
  ds_read_b32 v20, v3 offset:64
  ds_read_b32 v21, v3 offset:80
  ds_read_b32 v22, v3 offset:96
  ds_read_b32 v23, v3 offset:112
  s_waitcnt lgkmcnt(0)
  v_lshrrev_b32 v24, 16, v16
  v_lshrrev_b32 v25, 16, v17
  v_lshrrev_b32 v26, 16, v18
  v_lshrrev_b32 v27, 16, v19
  v_lshrrev_b32 v28, 16, v20
  v_lshrrev_b32 v29, 16, v21
  v_lshrrev_b32 v30, 16, v22
  v_lshrrev_b32 v31, 16, v23
  v_dot2_f32_bf16 v8, v48, v24, 0
  v_dot2_f32_bf16 v9, v48, v16, 0
  v_dot2_f32_bf16 v10, v49, v24, 0
  v_dot2_f32_bf16 v11, v49, v16, 0
  v_dot2_f32_bf16 v12, v50, v24, 0
  v_dot2_f32_bf16 v13, v50, v16, 0
  v_dot2_f32_bf16 v14, v51, v24, 0
  v_dot2_f32_bf16 v15, v51, v16, 0
  v_dot2_f32_bf16 v8, v52, v25, v8
  v_dot2_f32_bf16 v9, v52, v17, v9
  v_dot2_f32_bf16 v10, v53, v25, v10
  v_dot2_f32_bf16 v11, v53, v17, v11
  v_dot2_f32_bf16 v12, v54, v25, v12
  v_dot2_f32_bf16 v13, v54, v17, v13
  v_dot2_f32_bf16 v14, v55, v25, v14
  v_dot2_f32_bf16 v15, v55, v17, v15
  v_dot2_f32_bf16 v8, v56, v26, v8
  v_dot2_f32_bf16 v9, v56, v18, v9
  v_dot2_f32_bf16 v10, v57, v26, v10
  v_dot2_f32_bf16 v11, v57, v18, v11
  v_dot2_f32_bf16 v12, v58, v26, v12
  v_dot2_f32_bf16 v13, v58, v18, v13
  v_dot2_f32_bf16 v14, v59, v26, v14
  v_dot2_f32_bf16 v15, v59, v18, v15
  v_dot2_f32_bf16 v8, v60, v27, v8
  v_dot2_f32_bf16 v9, v60, v19, v9
  v_dot2_f32_bf16 v10, v61, v27, v10
  v_dot2_f32_bf16 v11, v61, v19, v11
  v_dot2_f32_bf16 v12, v62, v27, v12
  v_dot2_f32_bf16 v13, v62, v19, v13
  v_dot2_f32_bf16 v14, v63, v27, v14
  v_dot2_f32_bf16 v15, v63, v19, v15
  v_dot2_f32_bf16 v8, v64, v28, v8
  v_dot2_f32_bf16 v9, v64, v20, v9
  v_dot2_f32_bf16 v10, v65, v28, v10
  v_dot2_f32_bf16 v11, v65, v20, v11
  v_dot2_f32_bf16 v12, v66, v28, v12
  v_dot2_f32_bf16 v13, v66, v20, v13
  v_dot2_f32_bf16 v14, v67, v28, v14
  v_dot2_f32_bf16 v15, v67, v20, v15
  v_dot2_f32_bf16 v8, v68, v29, v8
  v_dot2_f32_bf16 v9, v68, v21, v9
  v_dot2_f32_bf16 v10, v69, v29, v10
  v_dot2_f32_bf16 v11, v69, v21, v11
  v_dot2_f32_bf16 v12, v70, v29, v12
  v_dot2_f32_bf16 v13, v70, v21, v13
  v_dot2_f32_bf16 v14, v71, v29, v14
  v_dot2_f32_bf16 v15, v71, v21, v15
  v_dot2_f32_bf16 v8, v72, v30, v8
  v_dot2_f32_bf16 v9, v72, v22, v9
  v_dot2_f32_bf16 v10, v73, v30, v10
  v_dot2_f32_bf16 v11, v73, v22, v11
  v_dot2_f32_bf16 v12, v74, v30, v12
  v_dot2_f32_bf16 v13, v74, v22, v13
  v_dot2_f32_bf16 v14, v75, v30, v14
  v_dot2_f32_bf16 v15, v75, v22, v15
  v_dot2_f32_bf16 v8, v76, v31, v8
  v_dot2_f32_bf16 v9, v76, v23, v9
  v_dot2_f32_bf16 v10, v77, v31, v10
  v_dot2_f32_bf16 v11, v77, v23, v11
  v_dot2_f32_bf16 v12, v78, v31, v12
  v_dot2_f32_bf16 v13, v78, v23, v13
  v_dot2_f32_bf16 v14, v79, v31, v14
  v_dot2_f32_bf16 v15, v79, v23, v15
  v_permlane32_swap_b32 v8, v9
  v_permlane32_swap_b32 v10, v11
  v_permlane32_swap_b32 v12, v13
  v_permlane32_swap_b32 v14, v15
  v_add_f32 v8, v8, v9
  v_add_f32 v10, v10, v11
  v_add_f32 v12, v12, v13
  v_add_f32 v14, v14, v15
  v_permlane16_swap_b32 v8, v10
  s_nop 0
  v_permlane16_swap_b32 v12, v14
  v_add_f32 v8, v8, v10
  v_add_f32 v12, v12, v14
  s_lshl_b32 s66, s60, 9
  v_lshlrev_b32 v3, 2, v46
  v_add_u32 v3, s66, v3
  v_add_u32 v3, 0x1000, v3
  ds_write2_b32 v3, v8, v12 offset0:0 offset1:4
  s_waitcnt lgkmcnt(0)
  s_barrier
  v_and_b32 v38, 7, v1
  v_lshrrev_b32 v39, 3, v1
  v_lshlrev_b32 v3, 9, v39
  v_lshl_add_u32 v3, v38, 2, v3
  s_lshl_b32 s66, s60, 5
  v_add_u32 v3, s66, v3
  ds_read_b32 v8, v3 offset:4096
  ds_read_b32 v9, v3 offset:8192
  s_waitcnt lgkmcnt(0)
  v_add_f32 v8, v8, v9
  s_nop 1
  v_add_f32_dpp v8, v8, v8 row_ror:8 row_mask:0xf bank_mask:0xf
  v_mov_b32 v9, v8
  s_nop 1
  v_permlane16_swap_b32 v8, v9
  v_add_f32 v8, v8, v9
  v_mov_b32 v9, v8
  s_nop 1
  v_permlane32_swap_b32 v8, v9
  v_add_f32 v8, v8, v9
  v_cvt_pk_bf16_f32 v8, v8, v8
  s_lshl_b32 s66, s60, 4
  v_lshlrev_b32 v3, 1, v38
  v_add_u32 v3, s66, v3
  ds_write_b16 v3, v8 offset:12288
  s_waitcnt lgkmcnt(0)
  s_barrier
  v_and_b32 v3, 15, v1
  v_lshlrev_b32 v3, 4, v3
  ds_read_b128 v[4:7], v3 offset:12288
  s_cmp_lg_u32 s60, 0
  s_cbranch_scc1 K1_NOFFN
  s_cmp_lg_u32 s65, 1
  s_cbranch_scc1 K1_NOFFN
  s_lshl_b32 s66, s64, 13
  v_lshlrev_b32 v3, 4, v1
  v_add_u32 v3, s66, v3
  s_mov_b32 s100, 0x0
  buffer_load_dwordx4 v[48:51], v3, s[52:55], s100 offen offset:0
  s_mov_b32 s100, 0x0
  buffer_load_dwordx4 v[52:55], v3, s[52:55], s100 offen offset:1024
  s_mov_b32 s100, 0x0
  buffer_load_dwordx4 v[56:59], v3, s[52:55], s100 offen offset:2048
  s_mov_b32 s100, 0x0
  buffer_load_dwordx4 v[60:63], v3, s[52:55], s100 offen offset:3072
  s_mov_b32 s100, 0x1000
  buffer_load_dwordx4 v[64:67], v3, s[52:55], s100 offen offset:0
  s_mov_b32 s100, 0x1000
  buffer_load_dwordx4 v[68:71], v3, s[52:55], s100 offen offset:1024
  s_mov_b32 s100, 0x1000
  buffer_load_dwordx4 v[72:75], v3, s[52:55], s100 offen offset:2048
  s_mov_b32 s100, 0x1000
  buffer_load_dwordx4 v[76:79], v3, s[52:55], s100 offen offset:3072
  v_lshlrev_b32 v38, 2, v1
  ds_read_b32 v8, v38 offset:12544
  ds_read_b32 v9, v38 offset:12800
  ds_read_b32 v10, v38 offset:13056
  ds_read_b32 v11, v38 offset:13312
  s_waitcnt lgkmcnt(0)
  v_add_f32 v8, v8, v9
  v_add_f32 v10, v10, v11
  v_mov_b32 v9, v8
  s_nop 1
  v_permlane16_swap_b32 v8, v9
  v_add_f32 v8, v8, v9
  v_mov_b32 v9, v8
  s_nop 1
  v_permlane32_swap_b32 v8, v9
  v_add_f32 v8, v8, v9
  v_mov_b32 v11, v10
  s_nop 1
  v_permlane16_swap_b32 v10, v11
  v_add_f32 v10, v10, v11
  v_mov_b32 v11, v10
  s_nop 1
  v_permlane32_swap_b32 v10, v11
  v_add_f32 v10, v10, v11
  v_cvt_pk_bf16_f32 v9, v8, v10
  v_lshlrev_b32 v8, 16, v9
  v_and_b32 v10, 0xffff0000, v9
  v_mul_f32 v9, v8, v8
  v_mov_b32 v11, 0x3f4c422a
  v_fmac_f32 v11, 0x3d12220c, v9
  v_mul_f32 v11, v11, v8
  v_mul_f32 v11, 0xc038aa3b, v11
  v_exp_f32 v11, v11
  s_nop 0
  v_add_f32 v11, 1.0, v11
  v_rcp_f32 v11, v11
  s_nop 0
  v_mul_f32 v8, v8, v11
  v_cvt_pk_bf16_f32 v9, v8, v8
  v_lshlrev_b32 v8, 16, v9
  v_mul_f32 v8, v8, v10
  v_cvt_pk_bf16_f32 v9, v8, v8
  v_lshlrev_b32 v8, 16, v9
  s_nop 0
  v_readlane_b32 s68, v8, 0
  v_readlane_b32 s69, v8, 1
  v_readlane_b32 s70, v8, 2
  v_readlane_b32 s71, v8, 3
  v_readlane_b32 s72, v8, 4
  v_readlane_b32 s73, v8, 5
  v_readlane_b32 s74, v8, 6
  v_readlane_b32 s75, v8, 7
  v_readlane_b32 s76, v8, 8
  v_readlane_b32 s77, v8, 9
  v_readlane_b32 s78, v8, 10
  v_readlane_b32 s79, v8, 11
  v_readlane_b32 s80, v8, 12
  v_readlane_b32 s81, v8, 13
  v_readlane_b32 s82, v8, 14
  v_readlane_b32 s83, v8, 15
  s_lshr_b32 s84, s68, 16
  s_lshr_b32 s85, s69, 16
  s_lshr_b32 s86, s70, 16
  s_lshr_b32 s87, s71, 16
  s_lshr_b32 s88, s72, 16
  s_lshr_b32 s89, s73, 16
  s_lshr_b32 s90, s74, 16
  s_lshr_b32 s91, s75, 16
  s_lshr_b32 s92, s76, 16
  s_lshr_b32 s93, s77, 16
  s_lshr_b32 s94, s78, 16
  s_lshr_b32 s95, s79, 16
  s_lshr_b32 s96, s80, 16
  s_lshr_b32 s97, s81, 16
  s_lshr_b32 s98, s82, 16
  s_lshr_b32 s99, s83, 16
  s_waitcnt vmcnt(0)
  v_dot2_f32_bf16 v8, v48, s84, 0
  v_dot2_f32_bf16 v9, v48, s68, 0
  v_dot2_f32_bf16 v16, v48, s92, 0
  v_dot2_f32_bf16 v17, v48, s76, 0
  v_dot2_f32_bf16 v10, v49, s84, 0
  v_dot2_f32_bf16 v11, v49, s68, 0
  v_dot2_f32_bf16 v18, v49, s92, 0
  v_dot2_f32_bf16 v19, v49, s76, 0
  v_dot2_f32_bf16 v12, v50, s84, 0
  v_dot2_f32_bf16 v13, v50, s68, 0
  v_dot2_f32_bf16 v20, v50, s92, 0
  v_dot2_f32_bf16 v21, v50, s76, 0
  v_dot2_f32_bf16 v14, v51, s84, 0
  v_dot2_f32_bf16 v15, v51, s68, 0
  v_dot2_f32_bf16 v22, v51, s92, 0
  v_dot2_f32_bf16 v23, v51, s76, 0
  v_dot2_f32_bf16 v8, v52, s85, v8
  v_dot2_f32_bf16 v9, v52, s69, v9
  v_dot2_f32_bf16 v16, v52, s93, v16
  v_dot2_f32_bf16 v17, v52, s77, v17
  v_dot2_f32_bf16 v10, v53, s85, v10
  v_dot2_f32_bf16 v11, v53, s69, v11
  v_dot2_f32_bf16 v18, v53, s93, v18
  v_dot2_f32_bf16 v19, v53, s77, v19
  v_dot2_f32_bf16 v12, v54, s85, v12
  v_dot2_f32_bf16 v13, v54, s69, v13
  v_dot2_f32_bf16 v20, v54, s93, v20
  v_dot2_f32_bf16 v21, v54, s77, v21
  v_dot2_f32_bf16 v14, v55, s85, v14
  v_dot2_f32_bf16 v15, v55, s69, v15
  v_dot2_f32_bf16 v22, v55, s93, v22
  v_dot2_f32_bf16 v23, v55, s77, v23
  v_dot2_f32_bf16 v8, v56, s86, v8
  v_dot2_f32_bf16 v9, v56, s70, v9
  v_dot2_f32_bf16 v16, v56, s94, v16
  v_dot2_f32_bf16 v17, v56, s78, v17
  v_dot2_f32_bf16 v10, v57, s86, v10
  v_dot2_f32_bf16 v11, v57, s70, v11
  v_dot2_f32_bf16 v18, v57, s94, v18
  v_dot2_f32_bf16 v19, v57, s78, v19
  v_dot2_f32_bf16 v12, v58, s86, v12
  v_dot2_f32_bf16 v13, v58, s70, v13
  v_dot2_f32_bf16 v20, v58, s94, v20
  v_dot2_f32_bf16 v21, v58, s78, v21
  v_dot2_f32_bf16 v14, v59, s86, v14
  v_dot2_f32_bf16 v15, v59, s70, v15
  v_dot2_f32_bf16 v22, v59, s94, v22
  v_dot2_f32_bf16 v23, v59, s78, v23
  v_dot2_f32_bf16 v8, v60, s87, v8
  v_dot2_f32_bf16 v9, v60, s71, v9
  v_dot2_f32_bf16 v16, v60, s95, v16
  v_dot2_f32_bf16 v17, v60, s79, v17
  v_dot2_f32_bf16 v10, v61, s87, v10
  v_dot2_f32_bf16 v11, v61, s71, v11
  v_dot2_f32_bf16 v18, v61, s95, v18
  v_dot2_f32_bf16 v19, v61, s79, v19
  v_dot2_f32_bf16 v12, v62, s87, v12
  v_dot2_f32_bf16 v13, v62, s71, v13
  v_dot2_f32_bf16 v20, v62, s95, v20
  v_dot2_f32_bf16 v21, v62, s79, v21
  v_dot2_f32_bf16 v14, v63, s87, v14
  v_dot2_f32_bf16 v15, v63, s71, v15
  v_dot2_f32_bf16 v22, v63, s95, v22
  v_dot2_f32_bf16 v23, v63, s79, v23
  v_dot2_f32_bf16 v8, v64, s88, v8
  v_dot2_f32_bf16 v9, v64, s72, v9
  v_dot2_f32_bf16 v16, v64, s96, v16
  v_dot2_f32_bf16 v17, v64, s80, v17
  v_dot2_f32_bf16 v10, v65, s88, v10
  v_dot2_f32_bf16 v11, v65, s72, v11
  v_dot2_f32_bf16 v18, v65, s96, v18
  v_dot2_f32_bf16 v19, v65, s80, v19
  v_dot2_f32_bf16 v12, v66, s88, v12
  v_dot2_f32_bf16 v13, v66, s72, v13
  v_dot2_f32_bf16 v20, v66, s96, v20
  v_dot2_f32_bf16 v21, v66, s80, v21
  v_dot2_f32_bf16 v14, v67, s88, v14
  v_dot2_f32_bf16 v15, v67, s72, v15
  v_dot2_f32_bf16 v22, v67, s96, v22
  v_dot2_f32_bf16 v23, v67, s80, v23
  v_dot2_f32_bf16 v8, v68, s89, v8
  v_dot2_f32_bf16 v9, v68, s73, v9
  v_dot2_f32_bf16 v16, v68, s97, v16
  v_dot2_f32_bf16 v17, v68, s81, v17
  v_dot2_f32_bf16 v10, v69, s89, v10
  v_dot2_f32_bf16 v11, v69, s73, v11
  v_dot2_f32_bf16 v18, v69, s97, v18
  v_dot2_f32_bf16 v19, v69, s81, v19
  v_dot2_f32_bf16 v12, v70, s89, v12
  v_dot2_f32_bf16 v13, v70, s73, v13
  v_dot2_f32_bf16 v20, v70, s97, v20
  v_dot2_f32_bf16 v21, v70, s81, v21
  v_dot2_f32_bf16 v14, v71, s89, v14
  v_dot2_f32_bf16 v15, v71, s73, v15
  v_dot2_f32_bf16 v22, v71, s97, v22
  v_dot2_f32_bf16 v23, v71, s81, v23
  v_dot2_f32_bf16 v8, v72, s90, v8
  v_dot2_f32_bf16 v9, v72, s74, v9
  v_dot2_f32_bf16 v16, v72, s98, v16
  v_dot2_f32_bf16 v17, v72, s82, v17
  v_dot2_f32_bf16 v10, v73, s90, v10
  v_dot2_f32_bf16 v11, v73, s74, v11
  v_dot2_f32_bf16 v18, v73, s98, v18
  v_dot2_f32_bf16 v19, v73, s82, v19
  v_dot2_f32_bf16 v12, v74, s90, v12
  v_dot2_f32_bf16 v13, v74, s74, v13
  v_dot2_f32_bf16 v20, v74, s98, v20
  v_dot2_f32_bf16 v21, v74, s82, v21
  v_dot2_f32_bf16 v14, v75, s90, v14
  v_dot2_f32_bf16 v15, v75, s74, v15
  v_dot2_f32_bf16 v22, v75, s98, v22
  v_dot2_f32_bf16 v23, v75, s82, v23
  v_dot2_f32_bf16 v8, v76, s91, v8
  v_dot2_f32_bf16 v9, v76, s75, v9
  v_dot2_f32_bf16 v16, v76, s99, v16
  v_dot2_f32_bf16 v17, v76, s83, v17
  v_dot2_f32_bf16 v10, v77, s91, v10
  v_dot2_f32_bf16 v11, v77, s75, v11
  v_dot2_f32_bf16 v18, v77, s99, v18
  v_dot2_f32_bf16 v19, v77, s83, v19
  v_dot2_f32_bf16 v12, v78, s91, v12
  v_dot2_f32_bf16 v13, v78, s75, v13
  v_dot2_f32_bf16 v20, v78, s99, v20
  v_dot2_f32_bf16 v21, v78, s83, v21
  v_dot2_f32_bf16 v14, v79, s91, v14
  v_dot2_f32_bf16 v15, v79, s75, v15
  v_dot2_f32_bf16 v22, v79, s99, v22
  v_dot2_f32_bf16 v23, v79, s83, v23
  s_lshl_b32 s66, s64, 12
  s_add_u32 s66, s66, 0x100000
  v_lshlrev_b32 v3, 5, v1
  v_add_u32 v3, s66, v3
  buffer_store_dwordx4 v[8:11], v3, s[56:59], 0 offen
  buffer_store_dwordx4 v[12:15], v3, s[56:59], 0 offen offset:16
  buffer_store_dwordx4 v[16:19], v3, s[56:59], 0 offen offset:2048
  buffer_store_dwordx4 v[20:23], v3, s[56:59], 0 offen offset:2064
  s_nop 4
K1_NOFFN:
  s_nop 4
  s_lshl_b32 s66, s61, 17
  s_lshl_b32 s67, s60, 13
  s_add_u32 s66, s66, s67
  v_lshlrev_b32 v3, 4, v1
  v_add_u32 v3, s66, v3
  s_mov_b32 s100, 0x0
  buffer_load_dwordx4 v[48:51], v3, s[40:43], s100 offen offset:0
  s_mov_b32 s100, 0x0
  buffer_load_dwordx4 v[52:55], v3, s[40:43], s100 offen offset:1024
  s_mov_b32 s100, 0x0
  buffer_load_dwordx4 v[56:59], v3, s[40:43], s100 offen offset:2048
  s_mov_b32 s100, 0x0
  buffer_load_dwordx4 v[60:63], v3, s[40:43], s100 offen offset:3072
  s_mov_b32 s100, 0x1000
  buffer_load_dwordx4 v[64:67], v3, s[40:43], s100 offen offset:0
  s_mov_b32 s100, 0x1000
  buffer_load_dwordx4 v[68:71], v3, s[40:43], s100 offen offset:1024
  s_mov_b32 s100, 0x1000
  buffer_load_dwordx4 v[72:75], v3, s[40:43], s100 offen offset:2048
  s_mov_b32 s100, 0x1000
  buffer_load_dwordx4 v[76:79], v3, s[40:43], s100 offen offset:3072
  s_waitcnt lgkmcnt(0)
  s_waitcnt vmcnt(19)
  v_dot2_f32_bf16 v32, v80, v4, 0
  v_dot2_f32_bf16 v32, v81, v5, v32
  v_dot2_f32_bf16 v32, v82, v6, v32
  v_dot2_f32_bf16 v32, v83, v7, v32
  buffer_load_dwordx4 v[80:83], v2, s[28:31], s101 offen nt
  s_add_u32 s101, s101, 0x400
  s_and_b32 s101, s101, 0x7fff
  s_waitcnt vmcnt(19)
  v_dot2_f32_bf16 v33, v84, v4, 0
  v_dot2_f32_bf16 v33, v85, v5, v33
  v_dot2_f32_bf16 v33, v86, v6, v33
  v_dot2_f32_bf16 v33, v87, v7, v33
  buffer_load_dwordx4 v[84:87], v2, s[28:31], s101 offen nt
  s_add_u32 s101, s101, 0x400
  s_and_b32 s101, s101, 0x7fff
  s_waitcnt vmcnt(19)
  v_dot2_f32_bf16 v34, v88, v4, 0
  v_dot2_f32_bf16 v34, v89, v5, v34
  v_dot2_f32_bf16 v34, v90, v6, v34
  v_dot2_f32_bf16 v34, v91, v7, v34
  buffer_load_dwordx4 v[88:91], v2, s[28:31], s101 offen nt
  s_add_u32 s101, s101, 0x400
  s_and_b32 s101, s101, 0x7fff
  s_waitcnt vmcnt(19)
  v_dot2_f32_bf16 v35, v92, v4, 0
  v_dot2_f32_bf16 v35, v93, v5, v35
  v_dot2_f32_bf16 v35, v94, v6, v35
  v_dot2_f32_bf16 v35, v95, v7, v35
  buffer_load_dwordx4 v[92:95], v2, s[28:31], s101 offen nt
  s_add_u32 s101, s101, 0x400
  s_and_b32 s101, s101, 0x7fff
  v_add_f32_dpp v32, v32, v32 quad_perm:[1,0,3,2] row_mask:0xf bank_mask:0xf
  v_add_f32_dpp v33, v33, v33 quad_perm:[1,0,3,2] row_mask:0xf bank_mask:0xf
  v_add_f32_dpp v34, v34, v34 quad_perm:[1,0,3,2] row_mask:0xf bank_mask:0xf
  v_add_f32_dpp v35, v35, v35 quad_perm:[1,0,3,2] row_mask:0xf bank_mask:0xf
  v_add_f32_dpp v32, v32, v32 quad_perm:[2,3,0,1] row_mask:0xf bank_mask:0xf
  v_add_f32_dpp v33, v33, v33 quad_perm:[2,3,0,1] row_mask:0xf bank_mask:0xf
  v_add_f32_dpp v34, v34, v34 quad_perm:[2,3,0,1] row_mask:0xf bank_mask:0xf
  v_add_f32_dpp v35, v35, v35 quad_perm:[2,3,0,1] row_mask:0xf bank_mask:0xf
  v_add_f32_dpp v36, v32, v32 row_half_mirror row_mask:0xf bank_mask:0x5
  v_add_f32_dpp v36, v33, v33 row_half_mirror row_mask:0xf bank_mask:0xa
  v_add_f32_dpp v37, v34, v34 row_half_mirror row_mask:0xf bank_mask:0x5
  v_add_f32_dpp v37, v35, v35 row_half_mirror row_mask:0xf bank_mask:0xa
  v_add_f32_dpp v16, v36, v36 row_ror:8 row_mask:0xf bank_mask:0x3
  s_nop 0
  v_add_f32_dpp v16, v37, v37 row_ror:8 row_mask:0xf bank_mask:0xc
  s_waitcnt vmcnt(19)
  v_dot2_f32_bf16 v32, v96, v4, 0
  v_dot2_f32_bf16 v32, v97, v5, v32
  v_dot2_f32_bf16 v32, v98, v6, v32
  v_dot2_f32_bf16 v32, v99, v7, v32
  buffer_load_dwordx4 v[96:99], v2, s[28:31], s101 offen nt
  s_add_u32 s101, s101, 0x400
  s_and_b32 s101, s101, 0x7fff
  s_waitcnt vmcnt(19)
  v_dot2_f32_bf16 v33, v100, v4, 0
  v_dot2_f32_bf16 v33, v101, v5, v33
  v_dot2_f32_bf16 v33, v102, v6, v33
  v_dot2_f32_bf16 v33, v103, v7, v33
  buffer_load_dwordx4 v[100:103], v2, s[28:31], s101 offen nt
  s_add_u32 s101, s101, 0x400
  s_and_b32 s101, s101, 0x7fff
  s_waitcnt vmcnt(19)
  v_dot2_f32_bf16 v34, v104, v4, 0
  v_dot2_f32_bf16 v34, v105, v5, v34
  v_dot2_f32_bf16 v34, v106, v6, v34
  v_dot2_f32_bf16 v34, v107, v7, v34
  buffer_load_dwordx4 v[104:107], v2, s[28:31], s101 offen nt
  s_add_u32 s101, s101, 0x400
  s_and_b32 s101, s101, 0x7fff
  s_waitcnt vmcnt(19)
  v_dot2_f32_bf16 v35, v108, v4, 0
  v_dot2_f32_bf16 v35, v109, v5, v35
  v_dot2_f32_bf16 v35, v110, v6, v35
  v_dot2_f32_bf16 v35, v111, v7, v35
  buffer_load_dwordx4 v[108:111], v2, s[28:31], s101 offen nt
  s_add_u32 s101, s101, 0x400
  s_and_b32 s101, s101, 0x7fff
  v_add_f32_dpp v32, v32, v32 quad_perm:[1,0,3,2] row_mask:0xf bank_mask:0xf
  v_add_f32_dpp v33, v33, v33 quad_perm:[1,0,3,2] row_mask:0xf bank_mask:0xf
  v_add_f32_dpp v34, v34, v34 quad_perm:[1,0,3,2] row_mask:0xf bank_mask:0xf
  v_add_f32_dpp v35, v35, v35 quad_perm:[1,0,3,2] row_mask:0xf bank_mask:0xf
  v_add_f32_dpp v32, v32, v32 quad_perm:[2,3,0,1] row_mask:0xf bank_mask:0xf
  v_add_f32_dpp v33, v33, v33 quad_perm:[2,3,0,1] row_mask:0xf bank_mask:0xf
  v_add_f32_dpp v34, v34, v34 quad_perm:[2,3,0,1] row_mask:0xf bank_mask:0xf
  v_add_f32_dpp v35, v35, v35 quad_perm:[2,3,0,1] row_mask:0xf bank_mask:0xf
  v_add_f32_dpp v36, v32, v32 row_half_mirror row_mask:0xf bank_mask:0x5
  v_add_f32_dpp v36, v33, v33 row_half_mirror row_mask:0xf bank_mask:0xa
  v_add_f32_dpp v37, v34, v34 row_half_mirror row_mask:0xf bank_mask:0x5
  v_add_f32_dpp v37, v35, v35 row_half_mirror row_mask:0xf bank_mask:0xa
  v_add_f32_dpp v17, v36, v36 row_ror:8 row_mask:0xf bank_mask:0x3
  s_nop 0
  v_add_f32_dpp v17, v37, v37 row_ror:8 row_mask:0xf bank_mask:0xc
  s_waitcnt vmcnt(19)
  v_dot2_f32_bf16 v32, v112, v4, 0
  v_dot2_f32_bf16 v32, v113, v5, v32
  v_dot2_f32_bf16 v32, v114, v6, v32
  v_dot2_f32_bf16 v32, v115, v7, v32
  buffer_load_dwordx4 v[112:115], v2, s[28:31], s101 offen nt
  s_add_u32 s101, s101, 0x400
  s_and_b32 s101, s101, 0x7fff
  s_waitcnt vmcnt(19)
  v_dot2_f32_bf16 v33, v116, v4, 0
  v_dot2_f32_bf16 v33, v117, v5, v33
  v_dot2_f32_bf16 v33, v118, v6, v33
  v_dot2_f32_bf16 v33, v119, v7, v33
  buffer_load_dwordx4 v[116:119], v2, s[28:31], s101 offen nt
  s_add_u32 s101, s101, 0x400
  s_and_b32 s101, s101, 0x7fff
  s_waitcnt vmcnt(19)
  v_dot2_f32_bf16 v34, v120, v4, 0
  v_dot2_f32_bf16 v34, v121, v5, v34
  v_dot2_f32_bf16 v34, v122, v6, v34
  v_dot2_f32_bf16 v34, v123, v7, v34
  buffer_load_dwordx4 v[120:123], v2, s[28:31], s101 offen nt
  s_add_u32 s101, s101, 0x400
  s_and_b32 s101, s101, 0x7fff
  s_waitcnt vmcnt(19)
  v_dot2_f32_bf16 v35, v124, v4, 0
  v_dot2_f32_bf16 v35, v125, v5, v35
  v_dot2_f32_bf16 v35, v126, v6, v35
  v_dot2_f32_bf16 v35, v127, v7, v35
  buffer_load_dwordx4 v[124:127], v2, s[28:31], s101 offen nt
  s_add_u32 s101, s101, 0x400
  s_and_b32 s101, s101, 0x7fff
  v_add_f32_dpp v32, v32, v32 quad_perm:[1,0,3,2] row_mask:0xf bank_mask:0xf
  v_add_f32_dpp v33, v33, v33 quad_perm:[1,0,3,2] row_mask:0xf bank_mask:0xf
  v_add_f32_dpp v34, v34, v34 quad_perm:[1,0,3,2] row_mask:0xf bank_mask:0xf
  v_add_f32_dpp v35, v35, v35 quad_perm:[1,0,3,2] row_mask:0xf bank_mask:0xf
  v_add_f32_dpp v32, v32, v32 quad_perm:[2,3,0,1] row_mask:0xf bank_mask:0xf
  v_add_f32_dpp v33, v33, v33 quad_perm:[2,3,0,1] row_mask:0xf bank_mask:0xf
  v_add_f32_dpp v34, v34, v34 quad_perm:[2,3,0,1] row_mask:0xf bank_mask:0xf
  v_add_f32_dpp v35, v35, v35 quad_perm:[2,3,0,1] row_mask:0xf bank_mask:0xf
  v_add_f32_dpp v36, v32, v32 row_half_mirror row_mask:0xf bank_mask:0x5
  v_add_f32_dpp v36, v33, v33 row_half_mirror row_mask:0xf bank_mask:0xa
  v_add_f32_dpp v37, v34, v34 row_half_mirror row_mask:0xf bank_mask:0x5
  v_add_f32_dpp v37, v35, v35 row_half_mirror row_mask:0xf bank_mask:0xa
  v_add_f32_dpp v18, v36, v36 row_ror:8 row_mask:0xf bank_mask:0x3
  s_nop 0
  v_add_f32_dpp v18, v37, v37 row_ror:8 row_mask:0xf bank_mask:0xc
  s_waitcnt vmcnt(11)
  v_dot2_f32_bf16 v32, v80, v4, 0
  v_dot2_f32_bf16 v32, v81, v5, v32
  v_dot2_f32_bf16 v32, v82, v6, v32
  v_dot2_f32_bf16 v32, v83, v7, v32
  buffer_load_dwordx4 v[80:83], v2, s[28:31], s101 offen nt
  s_add_u32 s101, s101, 0x400
  s_and_b32 s101, s101, 0x7fff
  s_waitcnt vmcnt(11)
  v_dot2_f32_bf16 v33, v84, v4, 0
  v_dot2_f32_bf16 v33, v85, v5, v33
  v_dot2_f32_bf16 v33, v86, v6, v33
  v_dot2_f32_bf16 v33, v87, v7, v33
  buffer_load_dwordx4 v[84:87], v2, s[28:31], s101 offen nt
  s_add_u32 s101, s101, 0x400
  s_and_b32 s101, s101, 0x7fff
  s_waitcnt vmcnt(11)
  v_dot2_f32_bf16 v34, v88, v4, 0
  v_dot2_f32_bf16 v34, v89, v5, v34
  v_dot2_f32_bf16 v34, v90, v6, v34
  v_dot2_f32_bf16 v34, v91, v7, v34
  buffer_load_dwordx4 v[88:91], v2, s[28:31], s101 offen nt
  s_add_u32 s101, s101, 0x400
  s_and_b32 s101, s101, 0x7fff
  s_waitcnt vmcnt(11)
  v_dot2_f32_bf16 v35, v92, v4, 0
  v_dot2_f32_bf16 v35, v93, v5, v35
  v_dot2_f32_bf16 v35, v94, v6, v35
  v_dot2_f32_bf16 v35, v95, v7, v35
  buffer_load_dwordx4 v[92:95], v2, s[28:31], s101 offen nt
  s_add_u32 s101, s101, 0x400
  s_and_b32 s101, s101, 0x7fff
  v_add_f32_dpp v32, v32, v32 quad_perm:[1,0,3,2] row_mask:0xf bank_mask:0xf
  v_add_f32_dpp v33, v33, v33 quad_perm:[1,0,3,2] row_mask:0xf bank_mask:0xf
  v_add_f32_dpp v34, v34, v34 quad_perm:[1,0,3,2] row_mask:0xf bank_mask:0xf
  v_add_f32_dpp v35, v35, v35 quad_perm:[1,0,3,2] row_mask:0xf bank_mask:0xf
  v_add_f32_dpp v32, v32, v32 quad_perm:[2,3,0,1] row_mask:0xf bank_mask:0xf
  v_add_f32_dpp v33, v33, v33 quad_perm:[2,3,0,1] row_mask:0xf bank_mask:0xf
  v_add_f32_dpp v34, v34, v34 quad_perm:[2,3,0,1] row_mask:0xf bank_mask:0xf
  v_add_f32_dpp v35, v35, v35 quad_perm:[2,3,0,1] row_mask:0xf bank_mask:0xf
  v_add_f32_dpp v36, v32, v32 row_half_mirror row_mask:0xf bank_mask:0x5
  v_add_f32_dpp v36, v33, v33 row_half_mirror row_mask:0xf bank_mask:0xa
  v_add_f32_dpp v37, v34, v34 row_half_mirror row_mask:0xf bank_mask:0x5
  v_add_f32_dpp v37, v35, v35 row_half_mirror row_mask:0xf bank_mask:0xa
  v_add_f32_dpp v19, v36, v36 row_ror:8 row_mask:0xf bank_mask:0x3
  s_nop 0
  v_add_f32_dpp v19, v37, v37 row_ror:8 row_mask:0xf bank_mask:0xc
  s_waitcnt vmcnt(11)
  v_dot2_f32_bf16 v32, v96, v4, 0
  v_dot2_f32_bf16 v32, v97, v5, v32
  v_dot2_f32_bf16 v32, v98, v6, v32
  v_dot2_f32_bf16 v32, v99, v7, v32
  buffer_load_dwordx4 v[96:99], v2, s[28:31], s101 offen nt
  s_add_u32 s101, s101, 0x400
  s_and_b32 s101, s101, 0x7fff
  s_waitcnt vmcnt(11)
  v_dot2_f32_bf16 v33, v100, v4, 0
  v_dot2_f32_bf16 v33, v101, v5, v33
  v_dot2_f32_bf16 v33, v102, v6, v33
  v_dot2_f32_bf16 v33, v103, v7, v33
  buffer_load_dwordx4 v[100:103], v2, s[28:31], s101 offen nt
  s_add_u32 s101, s101, 0x400
  s_and_b32 s101, s101, 0x7fff
  s_waitcnt vmcnt(11)
  v_dot2_f32_bf16 v34, v104, v4, 0
  v_dot2_f32_bf16 v34, v105, v5, v34
  v_dot2_f32_bf16 v34, v106, v6, v34
  v_dot2_f32_bf16 v34, v107, v7, v34
  buffer_load_dwordx4 v[104:107], v2, s[28:31], s101 offen nt
  s_add_u32 s101, s101, 0x400
  s_and_b32 s101, s101, 0x7fff
  s_waitcnt vmcnt(11)
  v_dot2_f32_bf16 v35, v108, v4, 0
  v_dot2_f32_bf16 v35, v109, v5, v35
  v_dot2_f32_bf16 v35, v110, v6, v35
  v_dot2_f32_bf16 v35, v111, v7, v35
  buffer_load_dwordx4 v[108:111], v2, s[28:31], s101 offen nt
  s_add_u32 s101, s101, 0x400
  s_and_b32 s101, s101, 0x7fff
  v_add_f32_dpp v32, v32, v32 quad_perm:[1,0,3,2] row_mask:0xf bank_mask:0xf
  v_add_f32_dpp v33, v33, v33 quad_perm:[1,0,3,2] row_mask:0xf bank_mask:0xf
  v_add_f32_dpp v34, v34, v34 quad_perm:[1,0,3,2] row_mask:0xf bank_mask:0xf
  v_add_f32_dpp v35, v35, v35 quad_perm:[1,0,3,2] row_mask:0xf bank_mask:0xf
  v_add_f32_dpp v32, v32, v32 quad_perm:[2,3,0,1] row_mask:0xf bank_mask:0xf
  v_add_f32_dpp v33, v33, v33 quad_perm:[2,3,0,1] row_mask:0xf bank_mask:0xf
  v_add_f32_dpp v34, v34, v34 quad_perm:[2,3,0,1] row_mask:0xf bank_mask:0xf
  v_add_f32_dpp v35, v35, v35 quad_perm:[2,3,0,1] row_mask:0xf bank_mask:0xf
  v_add_f32_dpp v36, v32, v32 row_half_mirror row_mask:0xf bank_mask:0x5
  v_add_f32_dpp v36, v33, v33 row_half_mirror row_mask:0xf bank_mask:0xa
  v_add_f32_dpp v37, v34, v34 row_half_mirror row_mask:0xf bank_mask:0x5
  v_add_f32_dpp v37, v35, v35 row_half_mirror row_mask:0xf bank_mask:0xa
  v_add_f32_dpp v20, v36, v36 row_ror:8 row_mask:0xf bank_mask:0x3
  s_nop 0
  v_add_f32_dpp v20, v37, v37 row_ror:8 row_mask:0xf bank_mask:0xc
  s_waitcnt vmcnt(11)
  v_dot2_f32_bf16 v32, v112, v4, 0
  v_dot2_f32_bf16 v32, v113, v5, v32
  v_dot2_f32_bf16 v32, v114, v6, v32
  v_dot2_f32_bf16 v32, v115, v7, v32
  buffer_load_dwordx4 v[112:115], v2, s[32:35], s101 offen nt
  s_add_u32 s101, s101, 0x400
  s_and_b32 s101, s101, 0x7fff
  s_waitcnt vmcnt(11)
  v_dot2_f32_bf16 v33, v116, v4, 0
  v_dot2_f32_bf16 v33, v117, v5, v33
  v_dot2_f32_bf16 v33, v118, v6, v33
  v_dot2_f32_bf16 v33, v119, v7, v33
  buffer_load_dwordx4 v[116:119], v2, s[32:35], s101 offen nt
  s_add_u32 s101, s101, 0x400
  s_and_b32 s101, s101, 0x7fff
  s_waitcnt vmcnt(11)
  v_dot2_f32_bf16 v34, v120, v4, 0
  v_dot2_f32_bf16 v34, v121, v5, v34
  v_dot2_f32_bf16 v34, v122, v6, v34
  v_dot2_f32_bf16 v34, v123, v7, v34
  buffer_load_dwordx4 v[120:123], v2, s[32:35], s101 offen nt
  s_add_u32 s101, s101, 0x400
  s_and_b32 s101, s101, 0x7fff
  s_waitcnt vmcnt(11)
  v_dot2_f32_bf16 v35, v124, v4, 0
  v_dot2_f32_bf16 v35, v125, v5, v35
  v_dot2_f32_bf16 v35, v126, v6, v35
  v_dot2_f32_bf16 v35, v127, v7, v35
  buffer_load_dwordx4 v[124:127], v2, s[32:35], s101 offen nt
  s_add_u32 s101, s101, 0x400
  s_and_b32 s101, s101, 0x7fff
  v_add_f32_dpp v32, v32, v32 quad_perm:[1,0,3,2] row_mask:0xf bank_mask:0xf
  v_add_f32_dpp v33, v33, v33 quad_perm:[1,0,3,2] row_mask:0xf bank_mask:0xf
  v_add_f32_dpp v34, v34, v34 quad_perm:[1,0,3,2] row_mask:0xf bank_mask:0xf
  v_add_f32_dpp v35, v35, v35 quad_perm:[1,0,3,2] row_mask:0xf bank_mask:0xf
  v_add_f32_dpp v32, v32, v32 quad_perm:[2,3,0,1] row_mask:0xf bank_mask:0xf
  v_add_f32_dpp v33, v33, v33 quad_perm:[2,3,0,1] row_mask:0xf bank_mask:0xf
  v_add_f32_dpp v34, v34, v34 quad_perm:[2,3,0,1] row_mask:0xf bank_mask:0xf
  v_add_f32_dpp v35, v35, v35 quad_perm:[2,3,0,1] row_mask:0xf bank_mask:0xf
  v_add_f32_dpp v36, v32, v32 row_half_mirror row_mask:0xf bank_mask:0x5
  v_add_f32_dpp v36, v33, v33 row_half_mirror row_mask:0xf bank_mask:0xa
  v_add_f32_dpp v37, v34, v34 row_half_mirror row_mask:0xf bank_mask:0x5
  v_add_f32_dpp v37, v35, v35 row_half_mirror row_mask:0xf bank_mask:0xa
  v_add_f32_dpp v21, v36, v36 row_ror:8 row_mask:0xf bank_mask:0x3
  s_nop 0
  v_add_f32_dpp v21, v37, v37 row_ror:8 row_mask:0xf bank_mask:0xc
  s_waitcnt vmcnt(11)
  v_dot2_f32_bf16 v32, v80, v4, 0
  v_dot2_f32_bf16 v32, v81, v5, v32
  v_dot2_f32_bf16 v32, v82, v6, v32
  v_dot2_f32_bf16 v32, v83, v7, v32
  buffer_load_dwordx4 v[80:83], v2, s[32:35], s101 offen nt
  s_add_u32 s101, s101, 0x400
  s_and_b32 s101, s101, 0x7fff
  s_waitcnt vmcnt(11)
  v_dot2_f32_bf16 v33, v84, v4, 0
  v_dot2_f32_bf16 v33, v85, v5, v33
  v_dot2_f32_bf16 v33, v86, v6, v33
  v_dot2_f32_bf16 v33, v87, v7, v33
  buffer_load_dwordx4 v[84:87], v2, s[32:35], s101 offen nt
  s_add_u32 s101, s101, 0x400
  s_and_b32 s101, s101, 0x7fff
  s_waitcnt vmcnt(11)
  v_dot2_f32_bf16 v34, v88, v4, 0
  v_dot2_f32_bf16 v34, v89, v5, v34
  v_dot2_f32_bf16 v34, v90, v6, v34
  v_dot2_f32_bf16 v34, v91, v7, v34
  buffer_load_dwordx4 v[88:91], v2, s[32:35], s101 offen nt
  s_add_u32 s101, s101, 0x400
  s_and_b32 s101, s101, 0x7fff
  s_waitcnt vmcnt(11)
  v_dot2_f32_bf16 v35, v92, v4, 0
  v_dot2_f32_bf16 v35, v93, v5, v35
  v_dot2_f32_bf16 v35, v94, v6, v35
  v_dot2_f32_bf16 v35, v95, v7, v35
  buffer_load_dwordx4 v[92:95], v2, s[32:35], s101 offen nt
  s_add_u32 s101, s101, 0x400
  s_and_b32 s101, s101, 0x7fff
  v_add_f32_dpp v32, v32, v32 quad_perm:[1,0,3,2] row_mask:0xf bank_mask:0xf
  v_add_f32_dpp v33, v33, v33 quad_perm:[1,0,3,2] row_mask:0xf bank_mask:0xf
  v_add_f32_dpp v34, v34, v34 quad_perm:[1,0,3,2] row_mask:0xf bank_mask:0xf
  v_add_f32_dpp v35, v35, v35 quad_perm:[1,0,3,2] row_mask:0xf bank_mask:0xf
  v_add_f32_dpp v32, v32, v32 quad_perm:[2,3,0,1] row_mask:0xf bank_mask:0xf
  v_add_f32_dpp v33, v33, v33 quad_perm:[2,3,0,1] row_mask:0xf bank_mask:0xf
  v_add_f32_dpp v34, v34, v34 quad_perm:[2,3,0,1] row_mask:0xf bank_mask:0xf
  v_add_f32_dpp v35, v35, v35 quad_perm:[2,3,0,1] row_mask:0xf bank_mask:0xf
  v_add_f32_dpp v36, v32, v32 row_half_mirror row_mask:0xf bank_mask:0x5
  v_add_f32_dpp v36, v33, v33 row_half_mirror row_mask:0xf bank_mask:0xa
  v_add_f32_dpp v37, v34, v34 row_half_mirror row_mask:0xf bank_mask:0x5
  v_add_f32_dpp v37, v35, v35 row_half_mirror row_mask:0xf bank_mask:0xa
  v_add_f32_dpp v22, v36, v36 row_ror:8 row_mask:0xf bank_mask:0x3
  s_nop 0
  v_add_f32_dpp v22, v37, v37 row_ror:8 row_mask:0xf bank_mask:0xc
  s_waitcnt vmcnt(11)
  v_dot2_f32_bf16 v32, v96, v4, 0
  v_dot2_f32_bf16 v32, v97, v5, v32
  v_dot2_f32_bf16 v32, v98, v6, v32
  v_dot2_f32_bf16 v32, v99, v7, v32
  buffer_load_dwordx4 v[96:99], v2, s[32:35], s101 offen nt
  s_add_u32 s101, s101, 0x400
  s_and_b32 s101, s101, 0x7fff
  s_waitcnt vmcnt(11)
  v_dot2_f32_bf16 v33, v100, v4, 0
  v_dot2_f32_bf16 v33, v101, v5, v33
  v_dot2_f32_bf16 v33, v102, v6, v33
  v_dot2_f32_bf16 v33, v103, v7, v33
  buffer_load_dwordx4 v[100:103], v2, s[32:35], s101 offen nt
  s_add_u32 s101, s101, 0x400
  s_and_b32 s101, s101, 0x7fff
  s_waitcnt vmcnt(11)
  v_dot2_f32_bf16 v34, v104, v4, 0
  v_dot2_f32_bf16 v34, v105, v5, v34
  v_dot2_f32_bf16 v34, v106, v6, v34
  v_dot2_f32_bf16 v34, v107, v7, v34
  buffer_load_dwordx4 v[104:107], v2, s[32:35], s101 offen nt
  s_add_u32 s101, s101, 0x400
  s_and_b32 s101, s101, 0x7fff
  s_waitcnt vmcnt(11)
  v_dot2_f32_bf16 v35, v108, v4, 0
  v_dot2_f32_bf16 v35, v109, v5, v35
  v_dot2_f32_bf16 v35, v110, v6, v35
  v_dot2_f32_bf16 v35, v111, v7, v35
  buffer_load_dwordx4 v[108:111], v2, s[32:35], s101 offen nt
  s_add_u32 s101, s101, 0x400
  s_and_b32 s101, s101, 0x7fff
  v_add_f32_dpp v32, v32, v32 quad_perm:[1,0,3,2] row_mask:0xf bank_mask:0xf
  v_add_f32_dpp v33, v33, v33 quad_perm:[1,0,3,2] row_mask:0xf bank_mask:0xf
  v_add_f32_dpp v34, v34, v34 quad_perm:[1,0,3,2] row_mask:0xf bank_mask:0xf
  v_add_f32_dpp v35, v35, v35 quad_perm:[1,0,3,2] row_mask:0xf bank_mask:0xf
  v_add_f32_dpp v32, v32, v32 quad_perm:[2,3,0,1] row_mask:0xf bank_mask:0xf
  v_add_f32_dpp v33, v33, v33 quad_perm:[2,3,0,1] row_mask:0xf bank_mask:0xf
  v_add_f32_dpp v34, v34, v34 quad_perm:[2,3,0,1] row_mask:0xf bank_mask:0xf
  v_add_f32_dpp v35, v35, v35 quad_perm:[2,3,0,1] row_mask:0xf bank_mask:0xf
  v_add_f32_dpp v36, v32, v32 row_half_mirror row_mask:0xf bank_mask:0x5
  v_add_f32_dpp v36, v33, v33 row_half_mirror row_mask:0xf bank_mask:0xa
  v_add_f32_dpp v37, v34, v34 row_half_mirror row_mask:0xf bank_mask:0x5
  v_add_f32_dpp v37, v35, v35 row_half_mirror row_mask:0xf bank_mask:0xa
  v_add_f32_dpp v23, v36, v36 row_ror:8 row_mask:0xf bank_mask:0x3
  s_nop 0
  v_add_f32_dpp v23, v37, v37 row_ror:8 row_mask:0xf bank_mask:0xc
  v_cvt_pk_bf16_f32 v38, v16, v17
  v_lshlrev_b32 v16, 16, v38
  v_and_b32 v17, 0xffff0000, v38
  v_mul_f32 v16, 0x3db504f3, v16
  v_mul_f32 v17, 0x3db504f3, v17
  v_cvt_pk_bf16_f32 v38, v16, v17
  v_lshlrev_b32 v16, 16, v38
  v_and_b32 v17, 0xffff0000, v38
  v_cvt_pk_bf16_f32 v38, v18, v19
  v_lshlrev_b32 v18, 16, v38
  v_and_b32 v19, 0xffff0000, v38
  v_mul_f32 v18, 0x3db504f3, v18
  v_mul_f32 v19, 0x3db504f3, v19
  v_cvt_pk_bf16_f32 v38, v18, v19
  v_lshlrev_b32 v18, 16, v38
  v_and_b32 v19, 0xffff0000, v38
  v_cvt_pk_bf16_f32 v38, v20, v21
  v_lshlrev_b32 v20, 16, v38
  v_and_b32 v21, 0xffff0000, v38
  v_mul_f32 v20, 0x3db504f3, v20
  v_mul_f32 v21, 0x3db504f3, v21
  v_cvt_pk_bf16_f32 v38, v20, v21
  v_lshlrev_b32 v20, 16, v38
  v_and_b32 v21, 0xffff0000, v38
  v_cvt_pk_bf16_f32 v38, v22, v23
  v_lshlrev_b32 v22, 16, v38
  v_and_b32 v23, 0xffff0000, v38
  v_mul_f32 v22, 0x3db504f3, v22
  v_mul_f32 v23, 0x3db504f3, v23
  v_cvt_pk_bf16_f32 v38, v22, v23
  v_lshlrev_b32 v22, 16, v38
  v_and_b32 v23, 0xffff0000, v38
  v_max3_f32 v40, v16, v17, v18
  v_max3_f32 v40, v40, v19, v20
  v_max3_f32 v40, v40, v21, v22
  v_max_f32 v40, v40, v23
  s_nop 1
  v_max_f32_dpp v40, v40, v40 row_ror:4 row_mask:0xf bank_mask:0xf
  s_nop 1
  v_max_f32_dpp v40, v40, v40 row_ror:8 row_mask:0xf bank_mask:0xf
  v_mov_b32 v38, v40
  s_nop 1
  v_permlane16_swap_b32 v40, v38
  v_max_f32 v40, v40, v38
  v_mov_b32 v38, v40
  s_nop 1
  v_permlane32_swap_b32 v40, v38
  v_max_f32 v40, v40, v38
  v_mul_f32 v39, 0x3fb8aa3b, v40
  s_mov_b32 s66, 0x3fb8aa3b
  v_fma_f32 v16, v16, s66, -v39
  v_fma_f32 v17, v17, s66, -v39
  v_fma_f32 v18, v18, s66, -v39
  v_fma_f32 v19, v19, s66, -v39
  v_fma_f32 v20, v20, s66, -v39
  v_fma_f32 v21, v21, s66, -v39
  v_fma_f32 v22, v22, s66, -v39
  v_fma_f32 v23, v23, s66, -v39
  v_exp_f32 v16, v16
  v_exp_f32 v17, v17
  v_exp_f32 v18, v18
  v_exp_f32 v19, v19
  v_exp_f32 v20, v20
  v_exp_f32 v21, v21
  v_exp_f32 v22, v22
  v_exp_f32 v23, v23
  v_add_f32 v41, v16, v17
  v_add_f32 v38, v18, v19
  v_add_f32 v39, v20, v21
  v_add_f32 v42, v22, v23
  v_add_f32 v41, v41, v38
  v_add_f32 v39, v39, v42
  v_add_f32 v41, v41, v39
  s_nop 1
  v_add_f32_dpp v41, v41, v41 row_ror:4 row_mask:0xf bank_mask:0xf
  s_nop 1
  v_add_f32_dpp v41, v41, v41 row_ror:8 row_mask:0xf bank_mask:0xf
  v_mov_b32 v38, v41
  s_nop 1
  v_permlane16_swap_b32 v41, v38
  v_add_f32 v41, v41, v38
  v_mov_b32 v38, v41
  s_nop 1
  v_permlane32_swap_b32 v41, v38
  v_add_f32 v41, v41, v38
  v_cvt_pk_bf16_f32 v38, v16, v17
  v_lshlrev_b32 v24, 16, v38
  v_and_b32 v25, 0xffff0000, v38
  v_and_b32 v16, 0xffff, v38
  v_lshrrev_b32 v17, 16, v38
  v_cvt_pk_bf16_f32 v38, v18, v19
  v_lshlrev_b32 v26, 16, v38
  v_and_b32 v27, 0xffff0000, v38
  v_and_b32 v18, 0xffff, v38
  v_lshrrev_b32 v19, 16, v38
  v_cvt_pk_bf16_f32 v38, v20, v21
  v_lshlrev_b32 v28, 16, v38
  v_and_b32 v29, 0xffff0000, v38
  v_and_b32 v20, 0xffff, v38
  v_lshrrev_b32 v21, 16, v38
  v_cvt_pk_bf16_f32 v38, v22, v23
  v_lshlrev_b32 v30, 16, v38
  v_and_b32 v31, 0xffff0000, v38
  v_and_b32 v22, 0xffff, v38
  v_lshrrev_b32 v23, 16, v38
  v_mov_b32 v8, 0
  v_mov_b32 v9, 0
  v_mov_b32 v10, 0
  v_mov_b32 v11, 0
  v_mov_b32 v12, 0
  v_mov_b32 v13, 0
  v_mov_b32 v14, 0
  v_mov_b32 v15, 0
  s_waitcnt vmcnt(11)
  v_dot2c_f32_bf16_dpp v8, v16, v112 row_newbcast:0 row_mask:0xf bank_mask:0xf
  v_dot2c_f32_bf16_dpp v9, v24, v112 row_newbcast:0 row_mask:0xf bank_mask:0xf
  v_dot2c_f32_bf16_dpp v10, v16, v113 row_newbcast:0 row_mask:0xf bank_mask:0xf
  v_dot2c_f32_bf16_dpp v11, v24, v113 row_newbcast:0 row_mask:0xf bank_mask:0xf
  v_dot2c_f32_bf16_dpp v12, v16, v114 row_newbcast:0 row_mask:0xf bank_mask:0xf
  v_dot2c_f32_bf16_dpp v13, v24, v114 row_newbcast:0 row_mask:0xf bank_mask:0xf
  v_dot2c_f32_bf16_dpp v14, v16, v115 row_newbcast:0 row_mask:0xf bank_mask:0xf
  v_dot2c_f32_bf16_dpp v15, v24, v115 row_newbcast:0 row_mask:0xf bank_mask:0xf
  buffer_load_dwordx4 v[112:115], v2, s[32:35], s101 offen nt
  s_add_u32 s101, s101, 0x400
  s_and_b32 s101, s101, 0x7fff
  s_waitcnt vmcnt(11)
  v_dot2c_f32_bf16_dpp v8, v16, v116 row_newbcast:4 row_mask:0xf bank_mask:0xf
  v_dot2c_f32_bf16_dpp v9, v24, v116 row_newbcast:4 row_mask:0xf bank_mask:0xf
  v_dot2c_f32_bf16_dpp v10, v16, v117 row_newbcast:4 row_mask:0xf bank_mask:0xf
  v_dot2c_f32_bf16_dpp v11, v24, v117 row_newbcast:4 row_mask:0xf bank_mask:0xf
  v_dot2c_f32_bf16_dpp v12, v16, v118 row_newbcast:4 row_mask:0xf bank_mask:0xf
  v_dot2c_f32_bf16_dpp v13, v24, v118 row_newbcast:4 row_mask:0xf bank_mask:0xf
  v_dot2c_f32_bf16_dpp v14, v16, v119 row_newbcast:4 row_mask:0xf bank_mask:0xf
  v_dot2c_f32_bf16_dpp v15, v24, v119 row_newbcast:4 row_mask:0xf bank_mask:0xf
  buffer_load_dwordx4 v[116:119], v2, s[32:35], s101 offen nt
  s_add_u32 s101, s101, 0x400
  s_and_b32 s101, s101, 0x7fff
  s_waitcnt vmcnt(11)
  v_dot2c_f32_bf16_dpp v8, v16, v120 row_newbcast:8 row_mask:0xf bank_mask:0xf
  v_dot2c_f32_bf16_dpp v9, v24, v120 row_newbcast:8 row_mask:0xf bank_mask:0xf
  v_dot2c_f32_bf16_dpp v10, v16, v121 row_newbcast:8 row_mask:0xf bank_mask:0xf
  v_dot2c_f32_bf16_dpp v11, v24, v121 row_newbcast:8 row_mask:0xf bank_mask:0xf
  v_dot2c_f32_bf16_dpp v12, v16, v122 row_newbcast:8 row_mask:0xf bank_mask:0xf
  v_dot2c_f32_bf16_dpp v13, v24, v122 row_newbcast:8 row_mask:0xf bank_mask:0xf
  v_dot2c_f32_bf16_dpp v14, v16, v123 row_newbcast:8 row_mask:0xf bank_mask:0xf
  v_dot2c_f32_bf16_dpp v15, v24, v123 row_newbcast:8 row_mask:0xf bank_mask:0xf
  buffer_load_dwordx4 v[120:123], v2, s[32:35], s101 offen nt
  s_add_u32 s101, s101, 0x400
  s_and_b32 s101, s101, 0x7fff
  s_waitcnt vmcnt(11)
  v_dot2c_f32_bf16_dpp v8, v16, v124 row_newbcast:12 row_mask:0xf bank_mask:0xf
  v_dot2c_f32_bf16_dpp v9, v24, v124 row_newbcast:12 row_mask:0xf bank_mask:0xf
  v_dot2c_f32_bf16_dpp v10, v16, v125 row_newbcast:12 row_mask:0xf bank_mask:0xf
  v_dot2c_f32_bf16_dpp v11, v24, v125 row_newbcast:12 row_mask:0xf bank_mask:0xf
  v_dot2c_f32_bf16_dpp v12, v16, v126 row_newbcast:12 row_mask:0xf bank_mask:0xf
  v_dot2c_f32_bf16_dpp v13, v24, v126 row_newbcast:12 row_mask:0xf bank_mask:0xf
  v_dot2c_f32_bf16_dpp v14, v16, v127 row_newbcast:12 row_mask:0xf bank_mask:0xf
  v_dot2c_f32_bf16_dpp v15, v24, v127 row_newbcast:12 row_mask:0xf bank_mask:0xf
  buffer_load_dwordx4 v[124:127], v2, s[32:35], s101 offen nt
  s_add_u32 s101, s101, 0x400
  s_and_b32 s101, s101, 0x7fff
  s_waitcnt vmcnt(11)
  v_dot2c_f32_bf16_dpp v8, v17, v80 row_newbcast:0 row_mask:0xf bank_mask:0xf
  v_dot2c_f32_bf16_dpp v9, v25, v80 row_newbcast:0 row_mask:0xf bank_mask:0xf
  v_dot2c_f32_bf16_dpp v10, v17, v81 row_newbcast:0 row_mask:0xf bank_mask:0xf
  v_dot2c_f32_bf16_dpp v11, v25, v81 row_newbcast:0 row_mask:0xf bank_mask:0xf
  v_dot2c_f32_bf16_dpp v12, v17, v82 row_newbcast:0 row_mask:0xf bank_mask:0xf
  v_dot2c_f32_bf16_dpp v13, v25, v82 row_newbcast:0 row_mask:0xf bank_mask:0xf
  v_dot2c_f32_bf16_dpp v14, v17, v83 row_newbcast:0 row_mask:0xf bank_mask:0xf
  v_dot2c_f32_bf16_dpp v15, v25, v83 row_newbcast:0 row_mask:0xf bank_mask:0xf
  buffer_load_dwordx4 v[80:83], v2, s[32:35], s101 offen nt
  s_add_u32 s101, s101, 0x400
  s_and_b32 s101, s101, 0x7fff
  s_waitcnt vmcnt(11)
  v_dot2c_f32_bf16_dpp v8, v17, v84 row_newbcast:4 row_mask:0xf bank_mask:0xf
  v_dot2c_f32_bf16_dpp v9, v25, v84 row_newbcast:4 row_mask:0xf bank_mask:0xf
  v_dot2c_f32_bf16_dpp v10, v17, v85 row_newbcast:4 row_mask:0xf bank_mask:0xf
  v_dot2c_f32_bf16_dpp v11, v25, v85 row_newbcast:4 row_mask:0xf bank_mask:0xf
  v_dot2c_f32_bf16_dpp v12, v17, v86 row_newbcast:4 row_mask:0xf bank_mask:0xf
  v_dot2c_f32_bf16_dpp v13, v25, v86 row_newbcast:4 row_mask:0xf bank_mask:0xf
  v_dot2c_f32_bf16_dpp v14, v17, v87 row_newbcast:4 row_mask:0xf bank_mask:0xf
  v_dot2c_f32_bf16_dpp v15, v25, v87 row_newbcast:4 row_mask:0xf bank_mask:0xf
  buffer_load_dwordx4 v[84:87], v2, s[32:35], s101 offen nt
  s_add_u32 s101, s101, 0x400
  s_and_b32 s101, s101, 0x7fff
  s_waitcnt vmcnt(11)
  v_dot2c_f32_bf16_dpp v8, v17, v88 row_newbcast:8 row_mask:0xf bank_mask:0xf
  v_dot2c_f32_bf16_dpp v9, v25, v88 row_newbcast:8 row_mask:0xf bank_mask:0xf
  v_dot2c_f32_bf16_dpp v10, v17, v89 row_newbcast:8 row_mask:0xf bank_mask:0xf
  v_dot2c_f32_bf16_dpp v11, v25, v89 row_newbcast:8 row_mask:0xf bank_mask:0xf
  v_dot2c_f32_bf16_dpp v12, v17, v90 row_newbcast:8 row_mask:0xf bank_mask:0xf
  v_dot2c_f32_bf16_dpp v13, v25, v90 row_newbcast:8 row_mask:0xf bank_mask:0xf
  v_dot2c_f32_bf16_dpp v14, v17, v91 row_newbcast:8 row_mask:0xf bank_mask:0xf
  v_dot2c_f32_bf16_dpp v15, v25, v91 row_newbcast:8 row_mask:0xf bank_mask:0xf
  buffer_load_dwordx4 v[88:91], v2, s[32:35], s101 offen nt
  s_add_u32 s101, s101, 0x400
  s_and_b32 s101, s101, 0x7fff
  s_waitcnt vmcnt(11)
  v_dot2c_f32_bf16_dpp v8, v17, v92 row_newbcast:12 row_mask:0xf bank_mask:0xf
  v_dot2c_f32_bf16_dpp v9, v25, v92 row_newbcast:12 row_mask:0xf bank_mask:0xf
  v_dot2c_f32_bf16_dpp v10, v17, v93 row_newbcast:12 row_mask:0xf bank_mask:0xf
  v_dot2c_f32_bf16_dpp v11, v25, v93 row_newbcast:12 row_mask:0xf bank_mask:0xf
  v_dot2c_f32_bf16_dpp v12, v17, v94 row_newbcast:12 row_mask:0xf bank_mask:0xf
  v_dot2c_f32_bf16_dpp v13, v25, v94 row_newbcast:12 row_mask:0xf bank_mask:0xf
  v_dot2c_f32_bf16_dpp v14, v17, v95 row_newbcast:12 row_mask:0xf bank_mask:0xf
  v_dot2c_f32_bf16_dpp v15, v25, v95 row_newbcast:12 row_mask:0xf bank_mask:0xf
  buffer_load_dwordx4 v[92:95], v2, s[32:35], s101 offen nt
  s_add_u32 s101, s101, 0x400
  s_and_b32 s101, s101, 0x7fff
  s_waitcnt vmcnt(11)
  v_dot2c_f32_bf16_dpp v8, v18, v96 row_newbcast:0 row_mask:0xf bank_mask:0xf
  v_dot2c_f32_bf16_dpp v9, v26, v96 row_newbcast:0 row_mask:0xf bank_mask:0xf
  v_dot2c_f32_bf16_dpp v10, v18, v97 row_newbcast:0 row_mask:0xf bank_mask:0xf
  v_dot2c_f32_bf16_dpp v11, v26, v97 row_newbcast:0 row_mask:0xf bank_mask:0xf
  v_dot2c_f32_bf16_dpp v12, v18, v98 row_newbcast:0 row_mask:0xf bank_mask:0xf
  v_dot2c_f32_bf16_dpp v13, v26, v98 row_newbcast:0 row_mask:0xf bank_mask:0xf
  v_dot2c_f32_bf16_dpp v14, v18, v99 row_newbcast:0 row_mask:0xf bank_mask:0xf
  v_dot2c_f32_bf16_dpp v15, v26, v99 row_newbcast:0 row_mask:0xf bank_mask:0xf
  buffer_load_dwordx4 v[96:99], v2, s[32:35], s101 offen nt
  s_add_u32 s101, s101, 0x400
  s_and_b32 s101, s101, 0x7fff
  s_waitcnt vmcnt(11)
  v_dot2c_f32_bf16_dpp v8, v18, v100 row_newbcast:4 row_mask:0xf bank_mask:0xf
  v_dot2c_f32_bf16_dpp v9, v26, v100 row_newbcast:4 row_mask:0xf bank_mask:0xf
  v_dot2c_f32_bf16_dpp v10, v18, v101 row_newbcast:4 row_mask:0xf bank_mask:0xf
  v_dot2c_f32_bf16_dpp v11, v26, v101 row_newbcast:4 row_mask:0xf bank_mask:0xf
  v_dot2c_f32_bf16_dpp v12, v18, v102 row_newbcast:4 row_mask:0xf bank_mask:0xf
  v_dot2c_f32_bf16_dpp v13, v26, v102 row_newbcast:4 row_mask:0xf bank_mask:0xf
  v_dot2c_f32_bf16_dpp v14, v18, v103 row_newbcast:4 row_mask:0xf bank_mask:0xf
  v_dot2c_f32_bf16_dpp v15, v26, v103 row_newbcast:4 row_mask:0xf bank_mask:0xf
  buffer_load_dwordx4 v[100:103], v2, s[32:35], s101 offen nt
  s_add_u32 s101, s101, 0x400
  s_and_b32 s101, s101, 0x7fff
  s_waitcnt vmcnt(11)
  v_dot2c_f32_bf16_dpp v8, v18, v104 row_newbcast:8 row_mask:0xf bank_mask:0xf
  v_dot2c_f32_bf16_dpp v9, v26, v104 row_newbcast:8 row_mask:0xf bank_mask:0xf
  v_dot2c_f32_bf16_dpp v10, v18, v105 row_newbcast:8 row_mask:0xf bank_mask:0xf
  v_dot2c_f32_bf16_dpp v11, v26, v105 row_newbcast:8 row_mask:0xf bank_mask:0xf
  v_dot2c_f32_bf16_dpp v12, v18, v106 row_newbcast:8 row_mask:0xf bank_mask:0xf
  v_dot2c_f32_bf16_dpp v13, v26, v106 row_newbcast:8 row_mask:0xf bank_mask:0xf
  v_dot2c_f32_bf16_dpp v14, v18, v107 row_newbcast:8 row_mask:0xf bank_mask:0xf
  v_dot2c_f32_bf16_dpp v15, v26, v107 row_newbcast:8 row_mask:0xf bank_mask:0xf
  buffer_load_dwordx4 v[104:107], v2, s[32:35], s101 offen nt
  s_add_u32 s101, s101, 0x400
  s_and_b32 s101, s101, 0x7fff
  s_waitcnt vmcnt(11)
  v_dot2c_f32_bf16_dpp v8, v18, v108 row_newbcast:12 row_mask:0xf bank_mask:0xf
  v_dot2c_f32_bf16_dpp v9, v26, v108 row_newbcast:12 row_mask:0xf bank_mask:0xf
  v_dot2c_f32_bf16_dpp v10, v18, v109 row_newbcast:12 row_mask:0xf bank_mask:0xf
  v_dot2c_f32_bf16_dpp v11, v26, v109 row_newbcast:12 row_mask:0xf bank_mask:0xf
  v_dot2c_f32_bf16_dpp v12, v18, v110 row_newbcast:12 row_mask:0xf bank_mask:0xf
  v_dot2c_f32_bf16_dpp v13, v26, v110 row_newbcast:12 row_mask:0xf bank_mask:0xf
  v_dot2c_f32_bf16_dpp v14, v18, v111 row_newbcast:12 row_mask:0xf bank_mask:0xf
  v_dot2c_f32_bf16_dpp v15, v26, v111 row_newbcast:12 row_mask:0xf bank_mask:0xf
  buffer_load_dwordx4 v[108:111], v2, s[32:35], s101 offen nt
  s_add_u32 s101, s101, 0x400
  s_and_b32 s101, s101, 0x7fff
  s_waitcnt vmcnt(11)
  v_dot2c_f32_bf16_dpp v8, v19, v112 row_newbcast:0 row_mask:0xf bank_mask:0xf
  v_dot2c_f32_bf16_dpp v9, v27, v112 row_newbcast:0 row_mask:0xf bank_mask:0xf
  v_dot2c_f32_bf16_dpp v10, v19, v113 row_newbcast:0 row_mask:0xf bank_mask:0xf
  v_dot2c_f32_bf16_dpp v11, v27, v113 row_newbcast:0 row_mask:0xf bank_mask:0xf
  v_dot2c_f32_bf16_dpp v12, v19, v114 row_newbcast:0 row_mask:0xf bank_mask:0xf
  v_dot2c_f32_bf16_dpp v13, v27, v114 row_newbcast:0 row_mask:0xf bank_mask:0xf
  v_dot2c_f32_bf16_dpp v14, v19, v115 row_newbcast:0 row_mask:0xf bank_mask:0xf
  v_dot2c_f32_bf16_dpp v15, v27, v115 row_newbcast:0 row_mask:0xf bank_mask:0xf
  buffer_load_dwordx4 v[112:115], v2, s[32:35], s101 offen nt
  s_add_u32 s101, s101, 0x400
  s_and_b32 s101, s101, 0x7fff
  s_waitcnt vmcnt(11)
  v_dot2c_f32_bf16_dpp v8, v19, v116 row_newbcast:4 row_mask:0xf bank_mask:0xf
  v_dot2c_f32_bf16_dpp v9, v27, v116 row_newbcast:4 row_mask:0xf bank_mask:0xf
  v_dot2c_f32_bf16_dpp v10, v19, v117 row_newbcast:4 row_mask:0xf bank_mask:0xf
  v_dot2c_f32_bf16_dpp v11, v27, v117 row_newbcast:4 row_mask:0xf bank_mask:0xf
  v_dot2c_f32_bf16_dpp v12, v19, v118 row_newbcast:4 row_mask:0xf bank_mask:0xf
  v_dot2c_f32_bf16_dpp v13, v27, v118 row_newbcast:4 row_mask:0xf bank_mask:0xf
  v_dot2c_f32_bf16_dpp v14, v19, v119 row_newbcast:4 row_mask:0xf bank_mask:0xf
  v_dot2c_f32_bf16_dpp v15, v27, v119 row_newbcast:4 row_mask:0xf bank_mask:0xf
  buffer_load_dwordx4 v[116:119], v2, s[32:35], s101 offen nt
  s_add_u32 s101, s101, 0x400
  s_and_b32 s101, s101, 0x7fff
  s_waitcnt vmcnt(11)
  v_dot2c_f32_bf16_dpp v8, v19, v120 row_newbcast:8 row_mask:0xf bank_mask:0xf
  v_dot2c_f32_bf16_dpp v9, v27, v120 row_newbcast:8 row_mask:0xf bank_mask:0xf
  v_dot2c_f32_bf16_dpp v10, v19, v121 row_newbcast:8 row_mask:0xf bank_mask:0xf
  v_dot2c_f32_bf16_dpp v11, v27, v121 row_newbcast:8 row_mask:0xf bank_mask:0xf
  v_dot2c_f32_bf16_dpp v12, v19, v122 row_newbcast:8 row_mask:0xf bank_mask:0xf
  v_dot2c_f32_bf16_dpp v13, v27, v122 row_newbcast:8 row_mask:0xf bank_mask:0xf
  v_dot2c_f32_bf16_dpp v14, v19, v123 row_newbcast:8 row_mask:0xf bank_mask:0xf
  v_dot2c_f32_bf16_dpp v15, v27, v123 row_newbcast:8 row_mask:0xf bank_mask:0xf
  buffer_load_dwordx4 v[120:123], v2, s[32:35], s101 offen nt
  s_add_u32 s101, s101, 0x400
  s_and_b32 s101, s101, 0x7fff
  s_waitcnt vmcnt(11)
  v_dot2c_f32_bf16_dpp v8, v19, v124 row_newbcast:12 row_mask:0xf bank_mask:0xf
  v_dot2c_f32_bf16_dpp v9, v27, v124 row_newbcast:12 row_mask:0xf bank_mask:0xf
  v_dot2c_f32_bf16_dpp v10, v19, v125 row_newbcast:12 row_mask:0xf bank_mask:0xf
  v_dot2c_f32_bf16_dpp v11, v27, v125 row_newbcast:12 row_mask:0xf bank_mask:0xf
  v_dot2c_f32_bf16_dpp v12, v19, v126 row_newbcast:12 row_mask:0xf bank_mask:0xf
  v_dot2c_f32_bf16_dpp v13, v27, v126 row_newbcast:12 row_mask:0xf bank_mask:0xf
  v_dot2c_f32_bf16_dpp v14, v19, v127 row_newbcast:12 row_mask:0xf bank_mask:0xf
  v_dot2c_f32_bf16_dpp v15, v27, v127 row_newbcast:12 row_mask:0xf bank_mask:0xf
  buffer_load_dwordx4 v[124:127], v2, s[32:35], s101 offen nt
  s_add_u32 s101, s101, 0x400
  s_and_b32 s101, s101, 0x7fff
  s_waitcnt vmcnt(11)
  v_dot2c_f32_bf16_dpp v8, v20, v80 row_newbcast:0 row_mask:0xf bank_mask:0xf
  v_dot2c_f32_bf16_dpp v9, v28, v80 row_newbcast:0 row_mask:0xf bank_mask:0xf
  v_dot2c_f32_bf16_dpp v10, v20, v81 row_newbcast:0 row_mask:0xf bank_mask:0xf
  v_dot2c_f32_bf16_dpp v11, v28, v81 row_newbcast:0 row_mask:0xf bank_mask:0xf
  v_dot2c_f32_bf16_dpp v12, v20, v82 row_newbcast:0 row_mask:0xf bank_mask:0xf
  v_dot2c_f32_bf16_dpp v13, v28, v82 row_newbcast:0 row_mask:0xf bank_mask:0xf
  v_dot2c_f32_bf16_dpp v14, v20, v83 row_newbcast:0 row_mask:0xf bank_mask:0xf
  v_dot2c_f32_bf16_dpp v15, v28, v83 row_newbcast:0 row_mask:0xf bank_mask:0xf
  buffer_load_dwordx4 v[80:83], v2, s[32:35], s101 offen nt
  s_add_u32 s101, s101, 0x400
  s_and_b32 s101, s101, 0x7fff
  s_waitcnt vmcnt(11)
  v_dot2c_f32_bf16_dpp v8, v20, v84 row_newbcast:4 row_mask:0xf bank_mask:0xf
  v_dot2c_f32_bf16_dpp v9, v28, v84 row_newbcast:4 row_mask:0xf bank_mask:0xf
  v_dot2c_f32_bf16_dpp v10, v20, v85 row_newbcast:4 row_mask:0xf bank_mask:0xf
  v_dot2c_f32_bf16_dpp v11, v28, v85 row_newbcast:4 row_mask:0xf bank_mask:0xf
  v_dot2c_f32_bf16_dpp v12, v20, v86 row_newbcast:4 row_mask:0xf bank_mask:0xf
  v_dot2c_f32_bf16_dpp v13, v28, v86 row_newbcast:4 row_mask:0xf bank_mask:0xf
  v_dot2c_f32_bf16_dpp v14, v20, v87 row_newbcast:4 row_mask:0xf bank_mask:0xf
  v_dot2c_f32_bf16_dpp v15, v28, v87 row_newbcast:4 row_mask:0xf bank_mask:0xf
  buffer_load_dwordx4 v[84:87], v2, s[32:35], s101 offen nt
  s_add_u32 s101, s101, 0x400
  s_and_b32 s101, s101, 0x7fff
  s_waitcnt vmcnt(11)
  v_dot2c_f32_bf16_dpp v8, v20, v88 row_newbcast:8 row_mask:0xf bank_mask:0xf
  v_dot2c_f32_bf16_dpp v9, v28, v88 row_newbcast:8 row_mask:0xf bank_mask:0xf
  v_dot2c_f32_bf16_dpp v10, v20, v89 row_newbcast:8 row_mask:0xf bank_mask:0xf
  v_dot2c_f32_bf16_dpp v11, v28, v89 row_newbcast:8 row_mask:0xf bank_mask:0xf
  v_dot2c_f32_bf16_dpp v12, v20, v90 row_newbcast:8 row_mask:0xf bank_mask:0xf
  v_dot2c_f32_bf16_dpp v13, v28, v90 row_newbcast:8 row_mask:0xf bank_mask:0xf
  v_dot2c_f32_bf16_dpp v14, v20, v91 row_newbcast:8 row_mask:0xf bank_mask:0xf
  v_dot2c_f32_bf16_dpp v15, v28, v91 row_newbcast:8 row_mask:0xf bank_mask:0xf
  buffer_load_dwordx4 v[88:91], v2, s[32:35], s101 offen nt
  s_add_u32 s101, s101, 0x400
  s_and_b32 s101, s101, 0x7fff
  s_waitcnt vmcnt(11)
  v_dot2c_f32_bf16_dpp v8, v20, v92 row_newbcast:12 row_mask:0xf bank_mask:0xf
  v_dot2c_f32_bf16_dpp v9, v28, v92 row_newbcast:12 row_mask:0xf bank_mask:0xf
  v_dot2c_f32_bf16_dpp v10, v20, v93 row_newbcast:12 row_mask:0xf bank_mask:0xf
  v_dot2c_f32_bf16_dpp v11, v28, v93 row_newbcast:12 row_mask:0xf bank_mask:0xf
  v_dot2c_f32_bf16_dpp v12, v20, v94 row_newbcast:12 row_mask:0xf bank_mask:0xf
  v_dot2c_f32_bf16_dpp v13, v28, v94 row_newbcast:12 row_mask:0xf bank_mask:0xf
  v_dot2c_f32_bf16_dpp v14, v20, v95 row_newbcast:12 row_mask:0xf bank_mask:0xf
  v_dot2c_f32_bf16_dpp v15, v28, v95 row_newbcast:12 row_mask:0xf bank_mask:0xf
  buffer_load_dwordx4 v[92:95], v2, s[32:35], s101 offen nt
  s_add_u32 s101, s101, 0x400
  s_and_b32 s101, s101, 0x7fff
  s_waitcnt vmcnt(11)
  v_dot2c_f32_bf16_dpp v8, v21, v96 row_newbcast:0 row_mask:0xf bank_mask:0xf
  v_dot2c_f32_bf16_dpp v9, v29, v96 row_newbcast:0 row_mask:0xf bank_mask:0xf
  v_dot2c_f32_bf16_dpp v10, v21, v97 row_newbcast:0 row_mask:0xf bank_mask:0xf
  v_dot2c_f32_bf16_dpp v11, v29, v97 row_newbcast:0 row_mask:0xf bank_mask:0xf
  v_dot2c_f32_bf16_dpp v12, v21, v98 row_newbcast:0 row_mask:0xf bank_mask:0xf
  v_dot2c_f32_bf16_dpp v13, v29, v98 row_newbcast:0 row_mask:0xf bank_mask:0xf
  v_dot2c_f32_bf16_dpp v14, v21, v99 row_newbcast:0 row_mask:0xf bank_mask:0xf
  v_dot2c_f32_bf16_dpp v15, v29, v99 row_newbcast:0 row_mask:0xf bank_mask:0xf
  s_waitcnt vmcnt(10)
  v_dot2c_f32_bf16_dpp v8, v21, v100 row_newbcast:4 row_mask:0xf bank_mask:0xf
  v_dot2c_f32_bf16_dpp v9, v29, v100 row_newbcast:4 row_mask:0xf bank_mask:0xf
  v_dot2c_f32_bf16_dpp v10, v21, v101 row_newbcast:4 row_mask:0xf bank_mask:0xf
  v_dot2c_f32_bf16_dpp v11, v29, v101 row_newbcast:4 row_mask:0xf bank_mask:0xf
  v_dot2c_f32_bf16_dpp v12, v21, v102 row_newbcast:4 row_mask:0xf bank_mask:0xf
  v_dot2c_f32_bf16_dpp v13, v29, v102 row_newbcast:4 row_mask:0xf bank_mask:0xf
  v_dot2c_f32_bf16_dpp v14, v21, v103 row_newbcast:4 row_mask:0xf bank_mask:0xf
  v_dot2c_f32_bf16_dpp v15, v29, v103 row_newbcast:4 row_mask:0xf bank_mask:0xf
  s_waitcnt vmcnt(9)
  v_dot2c_f32_bf16_dpp v8, v21, v104 row_newbcast:8 row_mask:0xf bank_mask:0xf
  v_dot2c_f32_bf16_dpp v9, v29, v104 row_newbcast:8 row_mask:0xf bank_mask:0xf
  v_dot2c_f32_bf16_dpp v10, v21, v105 row_newbcast:8 row_mask:0xf bank_mask:0xf
  v_dot2c_f32_bf16_dpp v11, v29, v105 row_newbcast:8 row_mask:0xf bank_mask:0xf
  v_dot2c_f32_bf16_dpp v12, v21, v106 row_newbcast:8 row_mask:0xf bank_mask:0xf
  v_dot2c_f32_bf16_dpp v13, v29, v106 row_newbcast:8 row_mask:0xf bank_mask:0xf
  v_dot2c_f32_bf16_dpp v14, v21, v107 row_newbcast:8 row_mask:0xf bank_mask:0xf
  v_dot2c_f32_bf16_dpp v15, v29, v107 row_newbcast:8 row_mask:0xf bank_mask:0xf
  s_waitcnt vmcnt(8)
  v_dot2c_f32_bf16_dpp v8, v21, v108 row_newbcast:12 row_mask:0xf bank_mask:0xf
  v_dot2c_f32_bf16_dpp v9, v29, v108 row_newbcast:12 row_mask:0xf bank_mask:0xf
  v_dot2c_f32_bf16_dpp v10, v21, v109 row_newbcast:12 row_mask:0xf bank_mask:0xf
  v_dot2c_f32_bf16_dpp v11, v29, v109 row_newbcast:12 row_mask:0xf bank_mask:0xf
  v_dot2c_f32_bf16_dpp v12, v21, v110 row_newbcast:12 row_mask:0xf bank_mask:0xf
  v_dot2c_f32_bf16_dpp v13, v29, v110 row_newbcast:12 row_mask:0xf bank_mask:0xf
  v_dot2c_f32_bf16_dpp v14, v21, v111 row_newbcast:12 row_mask:0xf bank_mask:0xf
  v_dot2c_f32_bf16_dpp v15, v29, v111 row_newbcast:12 row_mask:0xf bank_mask:0xf
  s_waitcnt vmcnt(7)
  v_dot2c_f32_bf16_dpp v8, v22, v112 row_newbcast:0 row_mask:0xf bank_mask:0xf
  v_dot2c_f32_bf16_dpp v9, v30, v112 row_newbcast:0 row_mask:0xf bank_mask:0xf
  v_dot2c_f32_bf16_dpp v10, v22, v113 row_newbcast:0 row_mask:0xf bank_mask:0xf
  v_dot2c_f32_bf16_dpp v11, v30, v113 row_newbcast:0 row_mask:0xf bank_mask:0xf
  v_dot2c_f32_bf16_dpp v12, v22, v114 row_newbcast:0 row_mask:0xf bank_mask:0xf
  v_dot2c_f32_bf16_dpp v13, v30, v114 row_newbcast:0 row_mask:0xf bank_mask:0xf
  v_dot2c_f32_bf16_dpp v14, v22, v115 row_newbcast:0 row_mask:0xf bank_mask:0xf
  v_dot2c_f32_bf16_dpp v15, v30, v115 row_newbcast:0 row_mask:0xf bank_mask:0xf
  s_waitcnt vmcnt(6)
  v_dot2c_f32_bf16_dpp v8, v22, v116 row_newbcast:4 row_mask:0xf bank_mask:0xf
  v_dot2c_f32_bf16_dpp v9, v30, v116 row_newbcast:4 row_mask:0xf bank_mask:0xf
  v_dot2c_f32_bf16_dpp v10, v22, v117 row_newbcast:4 row_mask:0xf bank_mask:0xf
  v_dot2c_f32_bf16_dpp v11, v30, v117 row_newbcast:4 row_mask:0xf bank_mask:0xf
  v_dot2c_f32_bf16_dpp v12, v22, v118 row_newbcast:4 row_mask:0xf bank_mask:0xf
  v_dot2c_f32_bf16_dpp v13, v30, v118 row_newbcast:4 row_mask:0xf bank_mask:0xf
  v_dot2c_f32_bf16_dpp v14, v22, v119 row_newbcast:4 row_mask:0xf bank_mask:0xf
  v_dot2c_f32_bf16_dpp v15, v30, v119 row_newbcast:4 row_mask:0xf bank_mask:0xf
  s_waitcnt vmcnt(5)
  v_dot2c_f32_bf16_dpp v8, v22, v120 row_newbcast:8 row_mask:0xf bank_mask:0xf
  v_dot2c_f32_bf16_dpp v9, v30, v120 row_newbcast:8 row_mask:0xf bank_mask:0xf
  v_dot2c_f32_bf16_dpp v10, v22, v121 row_newbcast:8 row_mask:0xf bank_mask:0xf
  v_dot2c_f32_bf16_dpp v11, v30, v121 row_newbcast:8 row_mask:0xf bank_mask:0xf
  v_dot2c_f32_bf16_dpp v12, v22, v122 row_newbcast:8 row_mask:0xf bank_mask:0xf
  v_dot2c_f32_bf16_dpp v13, v30, v122 row_newbcast:8 row_mask:0xf bank_mask:0xf
  v_dot2c_f32_bf16_dpp v14, v22, v123 row_newbcast:8 row_mask:0xf bank_mask:0xf
  v_dot2c_f32_bf16_dpp v15, v30, v123 row_newbcast:8 row_mask:0xf bank_mask:0xf
  s_waitcnt vmcnt(4)
  v_dot2c_f32_bf16_dpp v8, v22, v124 row_newbcast:12 row_mask:0xf bank_mask:0xf
  v_dot2c_f32_bf16_dpp v9, v30, v124 row_newbcast:12 row_mask:0xf bank_mask:0xf
  v_dot2c_f32_bf16_dpp v10, v22, v125 row_newbcast:12 row_mask:0xf bank_mask:0xf
  v_dot2c_f32_bf16_dpp v11, v30, v125 row_newbcast:12 row_mask:0xf bank_mask:0xf
  v_dot2c_f32_bf16_dpp v12, v22, v126 row_newbcast:12 row_mask:0xf bank_mask:0xf
  v_dot2c_f32_bf16_dpp v13, v30, v126 row_newbcast:12 row_mask:0xf bank_mask:0xf
  v_dot2c_f32_bf16_dpp v14, v22, v127 row_newbcast:12 row_mask:0xf bank_mask:0xf
  v_dot2c_f32_bf16_dpp v15, v30, v127 row_newbcast:12 row_mask:0xf bank_mask:0xf
  s_waitcnt vmcnt(3)
  v_dot2c_f32_bf16_dpp v8, v23, v80 row_newbcast:0 row_mask:0xf bank_mask:0xf
  v_dot2c_f32_bf16_dpp v9, v31, v80 row_newbcast:0 row_mask:0xf bank_mask:0xf
  v_dot2c_f32_bf16_dpp v10, v23, v81 row_newbcast:0 row_mask:0xf bank_mask:0xf
  v_dot2c_f32_bf16_dpp v11, v31, v81 row_newbcast:0 row_mask:0xf bank_mask:0xf
  v_dot2c_f32_bf16_dpp v12, v23, v82 row_newbcast:0 row_mask:0xf bank_mask:0xf
  v_dot2c_f32_bf16_dpp v13, v31, v82 row_newbcast:0 row_mask:0xf bank_mask:0xf
  v_dot2c_f32_bf16_dpp v14, v23, v83 row_newbcast:0 row_mask:0xf bank_mask:0xf
  v_dot2c_f32_bf16_dpp v15, v31, v83 row_newbcast:0 row_mask:0xf bank_mask:0xf
  s_waitcnt vmcnt(2)
  v_dot2c_f32_bf16_dpp v8, v23, v84 row_newbcast:4 row_mask:0xf bank_mask:0xf
  v_dot2c_f32_bf16_dpp v9, v31, v84 row_newbcast:4 row_mask:0xf bank_mask:0xf
  v_dot2c_f32_bf16_dpp v10, v23, v85 row_newbcast:4 row_mask:0xf bank_mask:0xf
  v_dot2c_f32_bf16_dpp v11, v31, v85 row_newbcast:4 row_mask:0xf bank_mask:0xf
  v_dot2c_f32_bf16_dpp v12, v23, v86 row_newbcast:4 row_mask:0xf bank_mask:0xf
  v_dot2c_f32_bf16_dpp v13, v31, v86 row_newbcast:4 row_mask:0xf bank_mask:0xf
  v_dot2c_f32_bf16_dpp v14, v23, v87 row_newbcast:4 row_mask:0xf bank_mask:0xf
  v_dot2c_f32_bf16_dpp v15, v31, v87 row_newbcast:4 row_mask:0xf bank_mask:0xf
  s_waitcnt vmcnt(1)
  v_dot2c_f32_bf16_dpp v8, v23, v88 row_newbcast:8 row_mask:0xf bank_mask:0xf
  v_dot2c_f32_bf16_dpp v9, v31, v88 row_newbcast:8 row_mask:0xf bank_mask:0xf
  v_dot2c_f32_bf16_dpp v10, v23, v89 row_newbcast:8 row_mask:0xf bank_mask:0xf
  v_dot2c_f32_bf16_dpp v11, v31, v89 row_newbcast:8 row_mask:0xf bank_mask:0xf
  v_dot2c_f32_bf16_dpp v12, v23, v90 row_newbcast:8 row_mask:0xf bank_mask:0xf
  v_dot2c_f32_bf16_dpp v13, v31, v90 row_newbcast:8 row_mask:0xf bank_mask:0xf
  v_dot2c_f32_bf16_dpp v14, v23, v91 row_newbcast:8 row_mask:0xf bank_mask:0xf
  v_dot2c_f32_bf16_dpp v15, v31, v91 row_newbcast:8 row_mask:0xf bank_mask:0xf
  s_waitcnt vmcnt(0)
  v_dot2c_f32_bf16_dpp v8, v23, v92 row_newbcast:12 row_mask:0xf bank_mask:0xf
  v_dot2c_f32_bf16_dpp v9, v31, v92 row_newbcast:12 row_mask:0xf bank_mask:0xf
  v_dot2c_f32_bf16_dpp v10, v23, v93 row_newbcast:12 row_mask:0xf bank_mask:0xf
  v_dot2c_f32_bf16_dpp v11, v31, v93 row_newbcast:12 row_mask:0xf bank_mask:0xf
  v_dot2c_f32_bf16_dpp v12, v23, v94 row_newbcast:12 row_mask:0xf bank_mask:0xf
  v_dot2c_f32_bf16_dpp v13, v31, v94 row_newbcast:12 row_mask:0xf bank_mask:0xf
  v_dot2c_f32_bf16_dpp v14, v23, v95 row_newbcast:12 row_mask:0xf bank_mask:0xf
  v_dot2c_f32_bf16_dpp v15, v31, v95 row_newbcast:12 row_mask:0xf bank_mask:0xf
  v_permlane32_swap_b32 v8, v9
  v_permlane32_swap_b32 v10, v11
  v_permlane32_swap_b32 v12, v13
  v_permlane32_swap_b32 v14, v15
  v_add_f32 v8, v8, v9
  v_add_f32 v10, v10, v11
  v_add_f32 v12, v12, v13
  v_add_f32 v14, v14, v15
  v_permlane16_swap_b32 v8, v10
  s_nop 0
  v_permlane16_swap_b32 v12, v14
  v_add_f32 v8, v8, v10
  v_add_f32 v12, v12, v14
  s_lshl_b32 s66, s60, 9
  v_lshlrev_b32 v3, 2, v46
  v_add_u32 v3, s66, v3
  v_add_u32 v3, 0x3600, v3
  ds_write2_b32 v3, v8, v12 offset0:0 offset1:4
  s_lshl_b32 s66, s60, 3
  v_mov_b32 v3, s66
  ds_write_b64 v3, v[40:41] offset:13568
  s_waitcnt lgkmcnt(0)
  s_barrier
  v_and_b32 v38, 7, v1
  v_lshrrev_b32 v39, 3, v1
  v_lshlrev_b32 v3, 3, v39
  ds_read_b64 v[16:17], v3 offset:13568
  ds_read_b64 v[18:19], v3 offset:13632
  v_lshlrev_b32 v3, 9, v39
  v_lshl_add_u32 v3, v38, 2, v3
  s_lshl_b32 s66, s60, 5
  v_add_u32 v3, s66, v3
  ds_read_b32 v20, v3 offset:13824
  ds_read_b32 v21, v3 offset:17920
  s_waitcnt lgkmcnt(0)
  v_max_f32 v22, v16, v18
  s_nop 1
  v_max_f32_dpp v22, v22, v22 row_ror:8 row_mask:0xf bank_mask:0xf
  v_mov_b32 v23, v22
  s_nop 1
  v_permlane16_swap_b32 v22, v23
  v_max_f32 v22, v22, v23
  v_mov_b32 v23, v22
  s_nop 1
  v_permlane32_swap_b32 v22, v23
  v_max_f32 v22, v22, v23
  v_sub_f32 v16, v16, v22
  v_sub_f32 v18, v18, v22
  v_mul_f32 v16, 0x3fb8aa3b, v16
  v_mul_f32 v18, 0x3fb8aa3b, v18
  v_exp_f32 v16, v16
  v_exp_f32 v18, v18
  v_mul_f32 v24, v16, v20
  v_mul_f32 v23, v16, v17
  v_fmac_f32 v24, v18, v21
  v_fmac_f32 v23, v18, v19
  s_nop 0
  v_add_f32_dpp v24, v24, v24 row_ror:8 row_mask:0xf bank_mask:0xf
  v_add_f32_dpp v23, v23, v23 row_ror:8 row_mask:0xf bank_mask:0xf
  v_mov_b32 v25, v24
  s_nop 1
  v_permlane16_swap_b32 v24, v25
  v_add_f32 v24, v24, v25
  v_mov_b32 v25, v24
  s_nop 1
  v_permlane32_swap_b32 v24, v25
  v_add_f32 v24, v24, v25
  v_mov_b32 v25, v23
  s_nop 1
  v_permlane16_swap_b32 v23, v25
  v_add_f32 v23, v23, v25
  v_mov_b32 v25, v23
  s_nop 1
  v_permlane32_swap_b32 v23, v25
  v_add_f32 v23, v23, v25
  s_cmp_lg_u32 s60, 0
  s_cbranch_scc1 K1_NOML
  s_lshl_b32 s66, s2, 3
  s_add_u32 s66, s66, 0x80000
  v_mov_b32 v3, s66
  buffer_store_dwordx2 v[22:23], v3, s[56:59], 0 offen
  s_nop 4
K1_NOML:
  s_nop 4
  s_waitcnt vmcnt(0)
  v_lshlrev_b32 v26, 16, v48
  v_and_b32 v27, 0xffff0000, v48
  s_nop 0
  v_mul_f32_dpp v8, v24, v26 row_newbcast:0 row_mask:0xf bank_mask:0xf
  v_mul_f32_dpp v9, v24, v27 row_newbcast:0 row_mask:0xf bank_mask:0xf
  v_lshlrev_b32 v26, 16, v49
  v_and_b32 v27, 0xffff0000, v49
  s_nop 0
  v_mul_f32_dpp v10, v24, v26 row_newbcast:0 row_mask:0xf bank_mask:0xf
  v_mul_f32_dpp v11, v24, v27 row_newbcast:0 row_mask:0xf bank_mask:0xf
  v_lshlrev_b32 v26, 16, v50
  v_and_b32 v27, 0xffff0000, v50
  s_nop 0
  v_mul_f32_dpp v12, v24, v26 row_newbcast:0 row_mask:0xf bank_mask:0xf
  v_mul_f32_dpp v13, v24, v27 row_newbcast:0 row_mask:0xf bank_mask:0xf
  v_lshlrev_b32 v26, 16, v51
  v_and_b32 v27, 0xffff0000, v51
  s_nop 0
  v_mul_f32_dpp v14, v24, v26 row_newbcast:0 row_mask:0xf bank_mask:0xf
  v_mul_f32_dpp v15, v24, v27 row_newbcast:0 row_mask:0xf bank_mask:0xf
  v_lshlrev_b32 v26, 16, v52
  v_and_b32 v27, 0xffff0000, v52
  s_nop 0
  v_fmac_f32_dpp v8, v24, v26 row_newbcast:1 row_mask:0xf bank_mask:0xf
  v_fmac_f32_dpp v9, v24, v27 row_newbcast:1 row_mask:0xf bank_mask:0xf
  v_lshlrev_b32 v26, 16, v53
  v_and_b32 v27, 0xffff0000, v53
  s_nop 0
  v_fmac_f32_dpp v10, v24, v26 row_newbcast:1 row_mask:0xf bank_mask:0xf
  v_fmac_f32_dpp v11, v24, v27 row_newbcast:1 row_mask:0xf bank_mask:0xf
  v_lshlrev_b32 v26, 16, v54
  v_and_b32 v27, 0xffff0000, v54
  s_nop 0
  v_fmac_f32_dpp v12, v24, v26 row_newbcast:1 row_mask:0xf bank_mask:0xf
  v_fmac_f32_dpp v13, v24, v27 row_newbcast:1 row_mask:0xf bank_mask:0xf
  v_lshlrev_b32 v26, 16, v55
  v_and_b32 v27, 0xffff0000, v55
  s_nop 0
  v_fmac_f32_dpp v14, v24, v26 row_newbcast:1 row_mask:0xf bank_mask:0xf
  v_fmac_f32_dpp v15, v24, v27 row_newbcast:1 row_mask:0xf bank_mask:0xf
  v_lshlrev_b32 v26, 16, v56
  v_and_b32 v27, 0xffff0000, v56
  s_nop 0
  v_fmac_f32_dpp v8, v24, v26 row_newbcast:2 row_mask:0xf bank_mask:0xf
  v_fmac_f32_dpp v9, v24, v27 row_newbcast:2 row_mask:0xf bank_mask:0xf
  v_lshlrev_b32 v26, 16, v57
  v_and_b32 v27, 0xffff0000, v57
  s_nop 0
  v_fmac_f32_dpp v10, v24, v26 row_newbcast:2 row_mask:0xf bank_mask:0xf
  v_fmac_f32_dpp v11, v24, v27 row_newbcast:2 row_mask:0xf bank_mask:0xf
  v_lshlrev_b32 v26, 16, v58
  v_and_b32 v27, 0xffff0000, v58
  s_nop 0
  v_fmac_f32_dpp v12, v24, v26 row_newbcast:2 row_mask:0xf bank_mask:0xf
  v_fmac_f32_dpp v13, v24, v27 row_newbcast:2 row_mask:0xf bank_mask:0xf
  v_lshlrev_b32 v26, 16, v59
  v_and_b32 v27, 0xffff0000, v59
  s_nop 0
  v_fmac_f32_dpp v14, v24, v26 row_newbcast:2 row_mask:0xf bank_mask:0xf
  v_fmac_f32_dpp v15, v24, v27 row_newbcast:2 row_mask:0xf bank_mask:0xf
  v_lshlrev_b32 v26, 16, v60
  v_and_b32 v27, 0xffff0000, v60
  s_nop 0
  v_fmac_f32_dpp v8, v24, v26 row_newbcast:3 row_mask:0xf bank_mask:0xf
  v_fmac_f32_dpp v9, v24, v27 row_newbcast:3 row_mask:0xf bank_mask:0xf
  v_lshlrev_b32 v26, 16, v61
  v_and_b32 v27, 0xffff0000, v61
  s_nop 0
  v_fmac_f32_dpp v10, v24, v26 row_newbcast:3 row_mask:0xf bank_mask:0xf
  v_fmac_f32_dpp v11, v24, v27 row_newbcast:3 row_mask:0xf bank_mask:0xf
  v_lshlrev_b32 v26, 16, v62
  v_and_b32 v27, 0xffff0000, v62
  s_nop 0
  v_fmac_f32_dpp v12, v24, v26 row_newbcast:3 row_mask:0xf bank_mask:0xf
  v_fmac_f32_dpp v13, v24, v27 row_newbcast:3 row_mask:0xf bank_mask:0xf
  v_lshlrev_b32 v26, 16, v63
  v_and_b32 v27, 0xffff0000, v63
  s_nop 0
  v_fmac_f32_dpp v14, v24, v26 row_newbcast:3 row_mask:0xf bank_mask:0xf
  v_fmac_f32_dpp v15, v24, v27 row_newbcast:3 row_mask:0xf bank_mask:0xf
  v_lshlrev_b32 v26, 16, v64
  v_and_b32 v27, 0xffff0000, v64
  s_nop 0
  v_fmac_f32_dpp v8, v24, v26 row_newbcast:4 row_mask:0xf bank_mask:0xf
  v_fmac_f32_dpp v9, v24, v27 row_newbcast:4 row_mask:0xf bank_mask:0xf
  v_lshlrev_b32 v26, 16, v65
  v_and_b32 v27, 0xffff0000, v65
  s_nop 0
  v_fmac_f32_dpp v10, v24, v26 row_newbcast:4 row_mask:0xf bank_mask:0xf
  v_fmac_f32_dpp v11, v24, v27 row_newbcast:4 row_mask:0xf bank_mask:0xf
  v_lshlrev_b32 v26, 16, v66
  v_and_b32 v27, 0xffff0000, v66
  s_nop 0
  v_fmac_f32_dpp v12, v24, v26 row_newbcast:4 row_mask:0xf bank_mask:0xf
  v_fmac_f32_dpp v13, v24, v27 row_newbcast:4 row_mask:0xf bank_mask:0xf
  v_lshlrev_b32 v26, 16, v67
  v_and_b32 v27, 0xffff0000, v67
  s_nop 0
  v_fmac_f32_dpp v14, v24, v26 row_newbcast:4 row_mask:0xf bank_mask:0xf
  v_fmac_f32_dpp v15, v24, v27 row_newbcast:4 row_mask:0xf bank_mask:0xf
  v_lshlrev_b32 v26, 16, v68
  v_and_b32 v27, 0xffff0000, v68
  s_nop 0
  v_fmac_f32_dpp v8, v24, v26 row_newbcast:5 row_mask:0xf bank_mask:0xf
  v_fmac_f32_dpp v9, v24, v27 row_newbcast:5 row_mask:0xf bank_mask:0xf
  v_lshlrev_b32 v26, 16, v69
  v_and_b32 v27, 0xffff0000, v69
  s_nop 0
  v_fmac_f32_dpp v10, v24, v26 row_newbcast:5 row_mask:0xf bank_mask:0xf
  v_fmac_f32_dpp v11, v24, v27 row_newbcast:5 row_mask:0xf bank_mask:0xf
  v_lshlrev_b32 v26, 16, v70
  v_and_b32 v27, 0xffff0000, v70
  s_nop 0
  v_fmac_f32_dpp v12, v24, v26 row_newbcast:5 row_mask:0xf bank_mask:0xf
  v_fmac_f32_dpp v13, v24, v27 row_newbcast:5 row_mask:0xf bank_mask:0xf
  v_lshlrev_b32 v26, 16, v71
  v_and_b32 v27, 0xffff0000, v71
  s_nop 0
  v_fmac_f32_dpp v14, v24, v26 row_newbcast:5 row_mask:0xf bank_mask:0xf
  v_fmac_f32_dpp v15, v24, v27 row_newbcast:5 row_mask:0xf bank_mask:0xf
  v_lshlrev_b32 v26, 16, v72
  v_and_b32 v27, 0xffff0000, v72
  s_nop 0
  v_fmac_f32_dpp v8, v24, v26 row_newbcast:6 row_mask:0xf bank_mask:0xf
  v_fmac_f32_dpp v9, v24, v27 row_newbcast:6 row_mask:0xf bank_mask:0xf
  v_lshlrev_b32 v26, 16, v73
  v_and_b32 v27, 0xffff0000, v73
  s_nop 0
  v_fmac_f32_dpp v10, v24, v26 row_newbcast:6 row_mask:0xf bank_mask:0xf
  v_fmac_f32_dpp v11, v24, v27 row_newbcast:6 row_mask:0xf bank_mask:0xf
  v_lshlrev_b32 v26, 16, v74
  v_and_b32 v27, 0xffff0000, v74
  s_nop 0
  v_fmac_f32_dpp v12, v24, v26 row_newbcast:6 row_mask:0xf bank_mask:0xf
  v_fmac_f32_dpp v13, v24, v27 row_newbcast:6 row_mask:0xf bank_mask:0xf
  v_lshlrev_b32 v26, 16, v75
  v_and_b32 v27, 0xffff0000, v75
  s_nop 0
  v_fmac_f32_dpp v14, v24, v26 row_newbcast:6 row_mask:0xf bank_mask:0xf
  v_fmac_f32_dpp v15, v24, v27 row_newbcast:6 row_mask:0xf bank_mask:0xf
  v_lshlrev_b32 v26, 16, v76
  v_and_b32 v27, 0xffff0000, v76
  s_nop 0
  v_fmac_f32_dpp v8, v24, v26 row_newbcast:7 row_mask:0xf bank_mask:0xf
  v_fmac_f32_dpp v9, v24, v27 row_newbcast:7 row_mask:0xf bank_mask:0xf
  v_lshlrev_b32 v26, 16, v77
  v_and_b32 v27, 0xffff0000, v77
  s_nop 0
  v_fmac_f32_dpp v10, v24, v26 row_newbcast:7 row_mask:0xf bank_mask:0xf
  v_fmac_f32_dpp v11, v24, v27 row_newbcast:7 row_mask:0xf bank_mask:0xf
  v_lshlrev_b32 v26, 16, v78
  v_and_b32 v27, 0xffff0000, v78
  s_nop 0
  v_fmac_f32_dpp v12, v24, v26 row_newbcast:7 row_mask:0xf bank_mask:0xf
  v_fmac_f32_dpp v13, v24, v27 row_newbcast:7 row_mask:0xf bank_mask:0xf
  v_lshlrev_b32 v26, 16, v79
  v_and_b32 v27, 0xffff0000, v79
  s_nop 0
  v_fmac_f32_dpp v14, v24, v26 row_newbcast:7 row_mask:0xf bank_mask:0xf
  v_fmac_f32_dpp v15, v24, v27 row_newbcast:7 row_mask:0xf bank_mask:0xf
  s_lshl_b32 s66, s60, 11
  v_lshlrev_b32 v3, 5, v1
  v_add_u32 v3, s66, v3
  ds_write_b128 v3, v[8:11] offset:22528
  ds_write_b128 v3, v[12:15] offset:22544
  s_waitcnt lgkmcnt(0)
  s_barrier
  s_cmp_ge_u32 s60, 8
  s_cbranch_scc1 K1_END
  v_lshlrev_b32 v3, 2, v0
  ds_read_b32 v16, v3 offset:22528
  ds_read_b32 v17, v3 offset:24576
  ds_read_b32 v18, v3 offset:26624
  ds_read_b32 v19, v3 offset:28672
  ds_read_b32 v20, v3 offset:30720
  ds_read_b32 v21, v3 offset:32768
  ds_read_b32 v22, v3 offset:34816
  ds_read_b32 v23, v3 offset:36864
  ds_read_b32 v24, v3 offset:38912
  ds_read_b32 v25, v3 offset:40960
  ds_read_b32 v26, v3 offset:43008
  ds_read_b32 v27, v3 offset:45056
  ds_read_b32 v28, v3 offset:47104
  ds_read_b32 v29, v3 offset:49152
  ds_read_b32 v30, v3 offset:51200
  ds_read_b32 v31, v3 offset:53248
  s_waitcnt lgkmcnt(0)
  v_add_f32 v16, v16, v24
  v_add_f32 v17, v17, v25
  v_add_f32 v18, v18, v26
  v_add_f32 v19, v19, v27
  v_add_f32 v20, v20, v28
  v_add_f32 v21, v21, v29
  v_add_f32 v22, v22, v30
  v_add_f32 v23, v23, v31
  v_add_f32 v16, v16, v20
  v_add_f32 v17, v17, v21
  v_add_f32 v18, v18, v22
  v_add_f32 v19, v19, v23
  v_add_f32 v16, v16, v18
  v_add_f32 v17, v17, v19
  v_add_f32 v16, v16, v17
  s_lshl_b32 s66, s2, 11
  v_add_u32 v3, s66, v3
  buffer_store_dword v16, v3, s[56:59], 0 offen
  s_nop 4
K1_END:
  s_nop 4
  s_endpgm
.globl combine_kernel
.p2align 8
.type combine_kernel,@function
combine_kernel:
  s_cmp_ge_u32 s2, 64
  s_cbranch_scc1 K2_END
  s_load_dwordx2 s[4:5], s[0:1], 0
  s_load_dwordx2 s[6:7], s[0:1], 72
  s_load_dwordx2 s[8:9], s[0:1], 88
  s_lshr_b32 s44, s2, 5
  s_and_b32 s45, s2, 31
  v_and_b32 v1, 3, v0
  v_lshrrev_b32 v2, 2, v0
  s_waitcnt lgkmcnt(0)
  s_mov_b32 s28, s8
  s_and_b32 s29, s9, 0xffff
  s_mov_b32 s30, 0x100000
  s_mov_b32 s31, 0x00020000
  s_mov_b32 s32, s8
  s_and_b32 s33, s9, 0xffff
  s_mov_b32 s34, 0x1ac000
  s_mov_b32 s35, 0x00020000
  s_mov_b32 s36, s4
  s_and_b32 s37, s5, 0xffff
  s_mov_b32 s38, 0x800
  s_mov_b32 s39, 0x00020000
  s_mov_b32 s40, s6
  s_and_b32 s41, s7, 0xffff
  s_mov_b32 s42, 0x800
  s_mov_b32 s43, 0x00020000
  s_lshl_b32 s46, s44, 18
  s_lshl_b32 s47, s45, 6
  s_add_u32 s46, s46, s47
  v_lshlrev_b32 v3, 11, v2
  v_lshl_add_u32 v3, v1, 4, v3
  v_add_u32 v4, s46, v3
  s_mov_b32 s48, 0x20000
  buffer_load_dwordx4 v[8:11], v4, s[28:31], 0 offen
  buffer_load_dwordx4 v[12:15], v4, s[28:31], s48 offen
  v_and_b32 v5, 31, v2
  v_lshlrev_b32 v5, 3, v5
  s_lshl_b32 s46, s44, 10
  s_add_u32 s46, s46, 0x80000
  v_add_u32 v5, s46, v5
  buffer_load_dwordx2 v[16:17], v5, s[28:31], 0 offen offset:0
  buffer_load_dwordx2 v[18:19], v5, s[28:31], 0 offen offset:256
  buffer_load_dwordx2 v[20:21], v5, s[28:31], 0 offen offset:512
  buffer_load_dwordx2 v[22:23], v5, s[28:31], 0 offen offset:768
  s_lshl_b32 s46, s44, 11
  s_add_u32 s46, s46, s47
  s_add_u32 s46, s46, 0x100000
  v_lshlrev_b32 v3, 12, v2
  v_lshl_add_u32 v3, v1, 4, v3
  v_add_u32 v4, s46, v3
  s_mov_b32 s48, 0x0
  buffer_load_dwordx4 v[24:27], v4, s[32:35], s48 offen
  s_mov_b32 s48, 0x40000
  buffer_load_dwordx4 v[28:31], v4, s[32:35], s48 offen
  s_mov_b32 s48, 0x80000
  buffer_load_dwordx4 v[32:35], v4, s[32:35], s48 offen
  s_lshl_b32 s46, s44, 10
  s_lshl_b32 s47, s45, 5
  s_add_u32 s46, s46, s47
  v_and_b32 v6, 15, v0
  v_lshlrev_b32 v6, 1, v6
  v_add_u32 v6, s46, v6
  buffer_load_ushort v7, v6, s[36:39], 0 offen
  s_waitcnt vmcnt(4)
  v_max3_f32 v36, v16, v18, v20
  v_max_f32 v36, v36, v22
  v_sub_f32 v16, v16, v36
  v_sub_f32 v18, v18, v36
  v_sub_f32 v20, v20, v36
  v_sub_f32 v22, v22, v36
  v_mul_f32 v16, 0x3fb8aa3b, v16
  v_mul_f32 v18, 0x3fb8aa3b, v18
  v_mul_f32 v20, 0x3fb8aa3b, v20
  v_mul_f32 v22, 0x3fb8aa3b, v22
  v_exp_f32 v16, v16
  v_exp_f32 v18, v18
  v_exp_f32 v20, v20
  v_exp_f32 v22, v22
  v_mul_f32 v36, v16, v17
  v_fmac_f32 v36, v18, v19
  v_fmac_f32 v36, v20, v21
  v_fmac_f32 v36, v22, v23
  v_rcp_f32 v37, v36
  s_nop 0
  v_fma_f32 v38, -v36, v37, 1.0
  v_fmac_f32 v37, v38, v37
  v_cmp_gt_u32 vcc, 32, v2
  s_nop 1
  v_cndmask_b32 v38, v18, v16, vcc
  v_cndmask_b32 v39, v22, v20, vcc
  v_mul_f32 v38, v38, v37
  v_mul_f32 v39, v39, v37
  v_mul_f32 v8, v38, v8
  v_mul_f32 v9, v38, v9
  v_mul_f32 v10, v38, v10
  v_mul_f32 v11, v38, v11
  v_fmac_f32 v8, v39, v12
  v_fmac_f32 v9, v39, v13
  v_fmac_f32 v10, v39, v14
  v_fmac_f32 v11, v39, v15
  s_waitcnt vmcnt(1)
  v_add_f32 v12, v24, v28
  v_add_f32 v13, v25, v29
  v_add_f32 v14, v26, v30
  v_add_f32 v15, v27, v31
  v_add_f32 v12, v12, v32
  v_add_f32 v13, v13, v33
  v_add_f32 v14, v14, v34
  v_add_f32 v15, v15, v35
  v_add_f32_dpp v8, v8, v8 row_ror:4 row_mask:0xf bank_mask:0xf
  v_add_f32_dpp v9, v9, v9 row_ror:4 row_mask:0xf bank_mask:0xf
  v_add_f32_dpp v10, v10, v10 row_ror:4 row_mask:0xf bank_mask:0xf
  v_add_f32_dpp v11, v11, v11 row_ror:4 row_mask:0xf bank_mask:0xf
  v_add_f32_dpp v12, v12, v12 row_ror:4 row_mask:0xf bank_mask:0xf
  v_add_f32_dpp v13, v13, v13 row_ror:4 row_mask:0xf bank_mask:0xf
  v_add_f32_dpp v14, v14, v14 row_ror:4 row_mask:0xf bank_mask:0xf
  v_add_f32_dpp v15, v15, v15 row_ror:4 row_mask:0xf bank_mask:0xf
  v_add_f32_dpp v8, v8, v8 row_ror:8 row_mask:0xf bank_mask:0xf
  v_add_f32_dpp v9, v9, v9 row_ror:8 row_mask:0xf bank_mask:0xf
  v_add_f32_dpp v10, v10, v10 row_ror:8 row_mask:0xf bank_mask:0xf
  v_add_f32_dpp v11, v11, v11 row_ror:8 row_mask:0xf bank_mask:0xf
  v_add_f32_dpp v12, v12, v12 row_ror:8 row_mask:0xf bank_mask:0xf
  v_add_f32_dpp v13, v13, v13 row_ror:8 row_mask:0xf bank_mask:0xf
  v_add_f32_dpp v14, v14, v14 row_ror:8 row_mask:0xf bank_mask:0xf
  v_add_f32_dpp v15, v15, v15 row_ror:8 row_mask:0xf bank_mask:0xf
  v_permlane32_swap_b32 v8, v9
  v_permlane32_swap_b32 v10, v11
  v_permlane32_swap_b32 v12, v13
  v_permlane32_swap_b32 v14, v15
  v_add_f32 v8, v8, v9
  v_add_f32 v10, v10, v11
  v_add_f32 v12, v12, v13
  v_add_f32 v14, v14, v15
  v_permlane16_swap_b32 v8, v10
  s_nop 0
  v_permlane16_swap_b32 v12, v14
  v_add_f32 v8, v8, v10
  v_add_f32 v12, v12, v14
  v_and_b32 v16, 63, v0
  v_lshrrev_b32 v17, 4, v16
  v_and_b32 v18, 1, v17
  v_lshlrev_b32 v18, 1, v18
  v_lshrrev_b32 v17, 1, v17
  v_or_b32 v18, v18, v17
  v_lshl_add_u32 v18, v1, 2, v18
  v_lshrrev_b32 v17, 6, v0
  v_lshl_add_u32 v18, v17, 5, v18
  v_lshlrev_b32 v18, 2, v18
  ds_write_b32 v18, v8
  ds_write_b32 v18, v12 offset:64
  s_waitcnt lgkmcnt(0)
  s_barrier
  v_cmp_gt_u32 vcc, 16, v0
  s_nop 0
  s_and_saveexec_b64 s[50:51], vcc
  s_cbranch_execz K2_END
  v_lshlrev_b32 v18, 2, v0
  ds_read_b32 v20, v18 offset:0
  ds_read_b32 v24, v18 offset:64
  ds_read_b32 v21, v18 offset:128
  ds_read_b32 v25, v18 offset:192
  ds_read_b32 v22, v18 offset:256
  ds_read_b32 v26, v18 offset:320
  ds_read_b32 v23, v18 offset:384
  ds_read_b32 v27, v18 offset:448
  s_waitcnt lgkmcnt(0)
  v_add_f32 v20, v20, v21
  v_add_f32 v22, v22, v23
  v_add_f32 v24, v24, v25
  v_add_f32 v26, v26, v27
  v_add_f32 v20, v20, v22
  v_add_f32 v24, v24, v26
  v_cvt_pk_bf16_f32 v21, v20, v24
  v_lshlrev_b32 v20, 16, v21
  v_and_b32 v24, 0xffff0000, v21
  v_mul_f32 v25, 0xbfb8aa3b, v24
  v_exp_f32 v25, v25
  s_nop 0
  v_add_f32 v25, 1.0, v25
  v_rcp_f32 v26, v25
  s_nop 0
  v_mul_f32 v27, v24, v26
  v_fma_f32 v28, -v27, v25, v24
  v_fmac_f32 v27, v28, v26
  v_cvt_pk_bf16_f32 v21, v27, v27
  v_lshlrev_b32 v27, 16, v21
  v_mul_f32 v20, v20, v27
  v_cvt_pk_bf16_f32 v21, v20, v20
  v_lshlrev_b32 v20, 16, v21
  s_waitcnt vmcnt(0)
  v_lshlrev_b32 v7, 16, v7
  v_add_f32 v20, v20, v7
  v_cvt_pk_bf16_f32 v20, v20, v20
  buffer_store_short v20, v6, s[40:43], 0 offen
  s_nop 4
K2_END:
  s_nop 4
  s_endpgm
.section .rodata,"a"
.p2align 6
.amdhsa_kernel recurrent_scan__gqa_block_cached__geglu_ffn__decode_kernel
  .amdhsa_next_free_vgpr 128
  .amdhsa_next_free_sgpr 102
  .amdhsa_accum_offset 128
  .amdhsa_group_segment_fixed_size 0
  .amdhsa_kernarg_size 96
  .amdhsa_user_sgpr_count 2
  .amdhsa_user_sgpr_kernarg_segment_ptr 1
  .amdhsa_system_sgpr_workgroup_id_x 1
.end_amdhsa_kernel
.p2align 6
.amdhsa_kernel combine_kernel
  .amdhsa_next_free_vgpr 40
  .amdhsa_next_free_sgpr 56
  .amdhsa_accum_offset 40
  .amdhsa_group_segment_fixed_size 0
  .amdhsa_kernarg_size 96
  .amdhsa_user_sgpr_count 2
  .amdhsa_user_sgpr_kernarg_segment_ptr 1
  .amdhsa_system_sgpr_workgroup_id_x 1
.end_amdhsa_kernel
```
